```python
import torch

def _softmax(x, axis=-1):
    return torch.softmax(x, dim=axis)
def _gelu(x):
    return torch.nn.functional.gelu(x, approximate="tanh")
def _silu(x):
    return torch.nn.functional.silu(x)
def _sigmoid(x):
    return torch.sigmoid(x)
def _layernorm(x, axis=-1, eps=1e-5):
    m = x.mean(dim=axis, keepdim=True)
    v = x.var(dim=axis, keepdim=True, unbiased=False)
    return (x - m) / torch.sqrt(v + eps)
def _scatter_add(tgt, idx, src, axis=0):
    return tgt.clone().index_add_(axis, idx, src)
def _segment_sum(src, seg, n):
    out = torch.zeros((n,) + src.shape[1:], dtype=src.dtype)
    return out.index_add_(0, seg, src)
def _pad(x, pw):
    flat = tuple(v for pair in reversed(pw) for v in pair)
    return torch.nn.functional.pad(x, flat)

kernel_name = 'interleave_layers__sliding_block_cached__dense_activation_gelu__decode'

def setup_inputs():

    _w = (lambda a: (lambda t: t.to(torch.bfloat16) if t.is_floating_point() else t)(torch.as_tensor(a)))
    def _A_setup():
        B, Sq, D = 4, 1, 576
        Hq, Hkv, Sk, Dh = 32, 16, 8192, 128
        assert Hq % Hkv == 0, (Hq, Hkv)
        return {
            "x": _w((lambda *s: torch.randn(*s, dtype=torch.bfloat16) * 0.05)(B, Sq, D)),
            "k_cache": _w((lambda *s: torch.randn(*s, dtype=torch.bfloat16) * 0.8)(B, Hkv, Sk, Dh)),
            "v_cache": _w((lambda *s: torch.randn(*s, dtype=torch.bfloat16) * 1.6)(B, Hkv, Sk, Dh)),
            "wq": _w((lambda *s: torch.randn(*s, dtype=torch.bfloat16) * 0.8)(D, Hq * Dh) * (D ** -0.5)),
            "wo": _w((lambda *s: torch.randn(*s, dtype=torch.bfloat16) * 1.6)(Hq * Dh, D) * ((Hq * Dh) ** -0.5)),
        }
    _A_in = _A_setup()

    def _B_setup():
        B, S, D, F = 4, 1, 576, 4608
        return {
            "x": _w((lambda *s: torch.randn(*s, dtype=torch.bfloat16) * 0.05)(B, S, D)),
            "w1": _w((lambda *s: torch.randn(*s, dtype=torch.bfloat16) * 0.4)(D, F) * (D ** -0.5)),
            "b1": _w((lambda *s: torch.randn(*s, dtype=torch.bfloat16) * 0.4)(F) * 0.01),
            "w2": _w((lambda *s: torch.randn(*s, dtype=torch.bfloat16) * 0.4)(F, D) * (F ** -0.5)),
            "b2": _w((lambda *s: torch.randn(*s, dtype=torch.bfloat16) * 0.4)(D) * 0.01),
        }
    _B_in = _B_setup()

    return {
        "A_x": _A_in["x"],
        "A_k_cache": _A_in["k_cache"],
        "A_v_cache": _A_in["v_cache"],
        "A_wq": _A_in["wq"],
        "A_wo": _A_in["wo"],
        "B_x": _B_in["x"],
        "B_w1": _B_in["w1"],
        "B_b1": _B_in["b1"],
        "B_w2": _B_in["w2"],
        "B_b2": _B_in["b2"],
    }

def reference(A_x, A_k_cache, A_v_cache, A_wq, A_wo, B_x, B_w1, B_b1, B_w2, B_b2):
    def _A_ref(x, k_cache, v_cache, wq, wo):
        B, Sq, D = x.shape
        Hq, Dh = 32, 128
        Hkv, Sk = k_cache.shape[1], k_cache.shape[2]
        W = min(4096, max(256, Sk // 4))
        rep = Hq // Hkv
        q = (lambda x, *d: x.permute(*d))((x @ wq).reshape(B, Sq, Hq, Dh), 0, 2, 1, 3)
        k = (lambda x, n, axis: torch.repeat_interleave(x, n, dim=axis))(k_cache[:, :, Sk - W:, :], rep, axis=1)
        v = (lambda x, n, axis: torch.repeat_interleave(x, n, dim=axis))(v_cache[:, :, Sk - W:, :], rep, axis=1)
        scores = torch.einsum("bhqd,bhkd->bhqk", q, k) * (Dh ** -0.5)
        p = _softmax(scores, axis=-1)
        o = torch.einsum("bhqk,bhkd->bhqd", p, v)
        return (lambda x, *d: x.permute(*d))(o, 0, 2, 1, 3).reshape(B, Sq, Hq * Dh) @ wo

    def _B_ref(x, w1, b1, w2, b2):
        h = torch.einsum("bsd,df->bsf", x, w1) + b1
        h = _gelu(h)
        return torch.einsum("bsf,fd->bsd", h, w2) + b2

    x = A_x
    x = x + _A_ref(_layernorm(x, axis=-1), A_k_cache, A_v_cache, A_wq, A_wo)
    x = x + _B_ref(_layernorm(x, axis=-1), B_w1, B_b1, B_w2, B_b2)
    x = x + _A_ref(_layernorm(x, axis=-1), A_k_cache, A_v_cache, A_wq, A_wo)
    x = x + _B_ref(_layernorm(x, axis=-1), B_w1, B_b1, B_w2, B_b2)
    return x
```

```asm
; @launch grid=(256,1,1) block=(512,1,1) lds=23552
.amdgcn_target "amdgcn-amd-amdhsa--gfx950"
.text
.globl interleave_layers__sliding_block_cached__dense_activation_gelu__decode_kernel
.p2align 8
.type interleave_layers__sliding_block_cached__dense_activation_gelu__decode_kernel,@function
interleave_layers__sliding_block_cached__dense_activation_gelu__decode_kernel:
    s_cmp_ge_u32 s2, 256
    s_cbranch_scc1 L_end
    s_load_dwordx2 s[56:57], s[0:1], 96
    s_load_dwordx16 s[32:47], s[0:1], 0
    s_load_dwordx8 s[48:55], s[0:1], 64
    v_lshrrev_b32 v1, 6, v0
    v_and_b32 v0, 63, v0
    v_readfirstlane_b32 s3, v1
    v_and_b32 v1, 15, v0
    v_lshrrev_b32 v2, 4, v0
    s_and_b32 s4, s2, 7
    s_lshr_b32 s5, s2, 3
    s_mov_b32 s8, 150000
    s_mov_b32 s9, 1
    s_cmp_ge_u32 s5, 9
    s_cselect_b32 s11, 1, 0
    s_mul_i32 s10, s11, 9
    s_sub_u32 s10, s5, s10
    s_sub_u32 s12, s5, 18
    s_mov_b32 s13, 99
    s_cmp_eq_u32 s3, 7
    s_cselect_b32 s13, s12, s13
    s_sub_u32 s15, s5, 13
    s_cmp_ge_u32 s5, 27
    s_cselect_b32 s15, s15, 99
    s_cmp_eq_u32 s3, 5
    s_cselect_b32 s13, s15, s13
    s_cmp_lt_u32 s3, 6
    s_cselect_b32 s72, 2, 0
    s_cmp_lt_u32 s12, 9
    s_cselect_b32 s72, s72, 0
    s_cmp_lt_u32 s5, 18
    s_cselect_b32 s72, 1, s72
    s_lshl_b32 s14, s4, 16
    s_add_u32 s14, s14, 1179648
    s_mov_b32 s58, 0x05040100
    s_mov_b32 s59, 0x07060302
    s_bfe_u32 s64, s5, 0x20001
    s_and_b32 s65, s5, 1
    s_lshr_b32 s66, s5, 3
    s_getreg_b32 s67, hwreg(HW_REG_XCC_ID)
    s_and_b32 s67, s67, 15
    v_and_b32 v4, 1, v0
    v_lshlrev_b32 v4, 4, v4
    v_mov_b32 v3, 0xffff
    v_lshlrev_b32 v3, v4, v3
    s_and_b32 s73, s5, 7
    s_lshl_b32 s60, s3, 12
    s_add_u32 s61, s60, 32768
    s_add_u32 s62, s60, 65536
    s_add_u32 s63, s60, 98304
    s_and_b32 s31, s3, 1
    v_and_b32 v50, 3, v1
    v_lshlrev_b32 v50, 10, v50
    v_lshrrev_b32 v51, 2, v1
    v_lshl_add_u32 v50, v51, 8, v50
    v_lshl_add_u32 v50, v2, 4, v50
    v_lshlrev_b32 v51, 4, v0
    v_mov_b32 v6, 0
    v_mov_b32 v44, 0
    v_mov_b32 v47, 0
    v_mov_b32 v74, 0
    v_mov_b32 v8, 0
    v_mov_b32 v9, 0
    v_mov_b32 v10, 0
    v_mov_b32 v11, 0
    v_mov_b32 v24, 0
    v_mov_b32 v25, 0
    v_mov_b32 v26, 0
    v_mov_b32 v27, 0
    v_mov_b32 v28, 0
    v_mov_b32 v29, 0
    v_mov_b32 v30, 0
    v_mov_b32 v31, 0
    v_mov_b32 v32, 0
    v_mov_b32 v33, 0
    v_mov_b32 v34, 0
    v_mov_b32 v35, 0
    v_mov_b32 v36, 0
    v_mov_b32 v37, 0
    v_mov_b32 v38, 0
    v_mov_b32 v39, 0
    v_mov_b32 v12, 0x3f803f80
    v_mov_b32 v13, 0x3f803f80
    v_mov_b32 v14, 0x3f803f80
    v_mov_b32 v15, 0x3f803f80
    s_lshl_b32 s15, s3, 10
    v_lshl_add_u32 v45, v0, 4, s15
    v_lshrrev_b32 v46, 2, v1
    v_mul_u32_u24 v46, 1152, v46
    v_lshl_add_u32 v46, v2, 4, v46
    s_waitcnt lgkmcnt(0)
    s_mov_b32 s16, s56
    s_mov_b32 s17, s57
    s_mov_b32 s18, 3145728
    s_mov_b32 s19, 0x20000
    s_cmp_lt_u32 s3, 5
    s_cbranch_scc0 Lskip_1
    s_mul_i32 s68, s66, 1179648
    s_lshl_b32 s69, s4, 10
    s_add_u32 s68, s68, s69
    s_lshl_b32 s69, s73, 7
    s_add_u32 s68, s68, s69
    s_add_u32 s28, s38, s68
    s_addc_u32 s29, s39, 0
    s_sub_u32 s30, 4718592, s68
    s_mov_b32 s31, 0x20000
    v_mul_u32_u24 v44, 65536, v2
    v_lshl_add_u32 v44, v1, 3, v44
    s_mul_i32 s15, s3, 262144
    v_add_u32 v44, s15, v44
    s_cmp_eq_u32 s3, 4
    s_cselect_b32 exec_hi, 0, -1
    s_mov_b32 s15, 0
    buffer_load_dwordx2 v[24:25], v44, s[28:31], s15 offen nt
    s_mov_b32 s15, 8192
    buffer_load_dwordx2 v[26:27], v44, s[28:31], s15 offen nt
    s_mov_b32 s15, 16384
    buffer_load_dwordx2 v[28:29], v44, s[28:31], s15 offen nt
    s_mov_b32 s15, 24576
    buffer_load_dwordx2 v[30:31], v44, s[28:31], s15 offen nt
    s_mov_b32 s15, 32768
    buffer_load_dwordx2 v[32:33], v44, s[28:31], s15 offen nt
    s_mov_b32 s15, 40960
    buffer_load_dwordx2 v[34:35], v44, s[28:31], s15 offen nt
    s_mov_b32 s15, 49152
    buffer_load_dwordx2 v[36:37], v44, s[28:31], s15 offen nt
    s_mov_b32 s15, 57344
    buffer_load_dwordx2 v[38:39], v44, s[28:31], s15 offen nt
    s_mov_b32 s28, s32
    s_mov_b32 s29, s33
    s_mov_b32 s30, 4608
    s_mov_b32 s31, 0x20000
    s_mul_i32 s15, s66, 288
    s_lshl_b32 s68, s3, 6
    s_add_u32 s15, s15, s68
    buffer_load_dwordx4 v[8:11], v46, s[28:31], s15 offen
    s_mov_b64 exec, -1
Lskip_1:
    buffer_load_dword v55, off, s[16:19], 0 sc1
    s_cmp_eq_u32 s3, 6
    s_cbranch_scc0 Lskip_2
    s_mov_b32 s28, s32
    s_mov_b32 s29, s33
    s_mov_b32 s30, 4608
    s_mov_b32 s31, 0x20000
    v_mul_u32_u24 v44, 1152, v2
    v_lshl_add_u32 v44, v1, 4, v44
    buffer_load_dwordx4 v[8:11], v44, s[28:31], 0 offen offset:0
    buffer_load_dwordx4 v[12:15], v44, s[28:31], 0 offen offset:256
    buffer_load_dwordx4 v[16:19], v44, s[28:31], 0 offen offset:512
    buffer_load_dwordx4 v[20:23], v44, s[28:31], 0 offen offset:768
    s_mov_b32 exec_lo, 0xff00ff
    s_mov_b32 exec_hi, 0xff00ff
    buffer_load_dwordx4 v[24:27], v44, s[28:31], 0 offen offset:1024
    s_mov_b64 exec, -1
Lskip_2:
    s_cmp_eq_u32 s3, 7
    s_cbranch_scc0 Lskip_3
    v_mov_b32 v4, -1
    v_mov_b32 v5, -1
    v_mov_b32 v6, -1
    v_mov_b32 v7, -1
    s_lshl_b32 s68, s5, 11
    s_add_u32 s68, s68, s14
    buffer_store_dwordx4 v[4:7], v51, s[16:19], s68 offen sc1
    buffer_store_dwordx4 v[4:7], v51, s[16:19], s68 offen offset:1024 sc1
Lskip_3:
    s_lshl_b32 s68, s64, 25
    s_lshl_b32 s69, s4, 22
    s_add_u32 s68, s68, s69
    s_lshl_b32 s69, s65, 21
    s_add_u32 s68, s68, s69
    s_lshl_b32 s69, s66, 17
    s_add_u32 s68, s68, s69
    s_add_u32 s68, s68, 1572864
    s_add_u32 s20, s34, s68
    s_addc_u32 s21, s35, 0
    s_mov_b32 s22, 0x20000
    s_mov_b32 s23, 0x20000
    s_add_u32 s24, s36, s68
    s_addc_u32 s25, s37, 0
    s_mov_b32 s26, 0x20000
    s_mov_b32 s27, 0x20000
    s_cmp_eq_u32 s3, 5
    s_cbranch_scc0 Lskip_4
    v_mov_b32 v4, 0
    v_mov_b32 v5, 0
    ds_write_b64 v4, v[4:5] offset:648
    s_waitcnt lgkmcnt(0)
Lskip_4:
    s_cmp_lg_u32 s3, 5
    s_cbranch_scc0 Lskip_5
    s_setprio 3
Lskip_5:
    s_barrier
    buffer_load_dwordx4 v[128:131], v50, s[20:23], s60 offen offset:0 nt
    buffer_load_dwordx4 v[132:135], v50, s[20:23], s60 offen offset:64 nt
    buffer_load_dwordx4 v[136:139], v50, s[20:23], s60 offen offset:128 nt
    buffer_load_dwordx4 v[140:143], v50, s[20:23], s60 offen offset:192 nt
    s_cmp_lt_u32 s3, 5
    s_cbranch_scc0 Lskip_6
    s_waitcnt vmcnt(5)
    v_perm_b32 v56, v26, v24, s58
    v_perm_b32 v60, v26, v24, s59
    v_perm_b32 v57, v30, v28, s58
    v_perm_b32 v61, v30, v28, s59
    v_perm_b32 v58, v34, v32, s58
    v_perm_b32 v62, v34, v32, s59
    v_perm_b32 v59, v38, v36, s58
    v_perm_b32 v63, v38, v36, s59
    v_perm_b32 v64, v27, v25, s58
    v_perm_b32 v68, v27, v25, s59
    v_perm_b32 v65, v31, v29, s58
    v_perm_b32 v69, v31, v29, s59
    v_perm_b32 v66, v35, v33, s58
    v_perm_b32 v70, v35, v33, s59
    v_perm_b32 v67, v39, v37, s58
    v_perm_b32 v71, v39, v37, s59
    v_mfma_f32_16x16x32_bf16 v[24:27], v[8:11], v[56:59], 0
    v_mfma_f32_16x16x32_bf16 v[28:31], v[8:11], v[60:63], 0
    v_mfma_f32_16x16x32_bf16 v[32:35], v[8:11], v[64:67], 0
    v_mfma_f32_16x16x32_bf16 v[36:39], v[8:11], v[68:71], 0
    v_mfma_f32_16x16x32_bf16 v[72:75], v[12:15], v[56:59], 0
    v_mfma_f32_16x16x32_bf16 v[76:79], v[12:15], v[60:63], 0
    v_mfma_f32_16x16x32_bf16 v[80:83], v[12:15], v[64:67], 0
    v_mfma_f32_16x16x32_bf16 v[84:87], v[12:15], v[68:71], 0
    v_add_u32 v47, 17408, v45
    v_add_u32 v45, 9216, v45
    ds_write2_b32 v45, v24, v28 offset0:0 offset1:1
    s_nop 0
    ds_write2_b32 v45, v32, v36 offset0:2 offset1:3
    s_nop 0
    ds_write2_b32 v47, v72, v76 offset0:0 offset1:1
    s_nop 0
    ds_write2_b32 v47, v80, v84 offset0:2 offset1:3
    s_waitcnt lgkmcnt(0)
    v_mov_b32 v4, 0
    v_mov_b32 v5, 1
    s_mov_b64 exec, 1
    ds_add_u32 v4, v5 offset:648
    s_mov_b64 exec, -1
Lskip_6:
    s_cmp_eq_u32 s3, 6
    s_cbranch_scc0 Lskip_7
    s_waitcnt vmcnt(4)
    v_mov_b32 v28, 0x3f803f80
    v_mov_b32 v48, 0
    v_mov_b32 v49, 0
    v_dot2_f32_bf16 v48, v8, v28, v48
    v_dot2_f32_bf16 v48, v9, v28, v48
    v_dot2_f32_bf16 v48, v10, v28, v48
    v_dot2_f32_bf16 v48, v11, v28, v48
    v_dot2_f32_bf16 v48, v12, v28, v48
    v_dot2_f32_bf16 v48, v13, v28, v48
    v_dot2_f32_bf16 v48, v14, v28, v48
    v_dot2_f32_bf16 v48, v15, v28, v48
    v_dot2_f32_bf16 v48, v16, v28, v48
    v_dot2_f32_bf16 v48, v17, v28, v48
    v_dot2_f32_bf16 v48, v18, v28, v48
    v_dot2_f32_bf16 v48, v19, v28, v48
    v_dot2_f32_bf16 v48, v20, v28, v48
    v_dot2_f32_bf16 v48, v21, v28, v48
    v_dot2_f32_bf16 v48, v22, v28, v48
    v_dot2_f32_bf16 v48, v23, v28, v48
    v_dot2_f32_bf16 v48, v24, v28, v48
    v_dot2_f32_bf16 v48, v25, v28, v48
    v_dot2_f32_bf16 v48, v26, v28, v48
    v_dot2_f32_bf16 v48, v27, v28, v48
    v_dot2_f32_bf16 v49, v8, v8, v49
    v_dot2_f32_bf16 v49, v9, v9, v49
    v_dot2_f32_bf16 v49, v10, v10, v49
    v_dot2_f32_bf16 v49, v11, v11, v49
    v_dot2_f32_bf16 v49, v12, v12, v49
    v_dot2_f32_bf16 v49, v13, v13, v49
    v_dot2_f32_bf16 v49, v14, v14, v49
    v_dot2_f32_bf16 v49, v15, v15, v49
    v_dot2_f32_bf16 v49, v16, v16, v49
    v_dot2_f32_bf16 v49, v17, v17, v49
    v_dot2_f32_bf16 v49, v18, v18, v49
    v_dot2_f32_bf16 v49, v19, v19, v49
    v_dot2_f32_bf16 v49, v20, v20, v49
    v_dot2_f32_bf16 v49, v21, v21, v49
    v_dot2_f32_bf16 v49, v22, v22, v49
    v_dot2_f32_bf16 v49, v23, v23, v49
    v_dot2_f32_bf16 v49, v24, v24, v49
    v_dot2_f32_bf16 v49, v25, v25, v49
    v_dot2_f32_bf16 v49, v26, v26, v49
    v_dot2_f32_bf16 v49, v27, v27, v49
    v_add_f32_dpp v48, v48, v48 row_ror:8 row_mask:0xf bank_mask:0xf
    s_nop 1
    v_add_f32_dpp v49, v49, v49 row_ror:8 row_mask:0xf bank_mask:0xf
    v_add_f32_dpp v48, v48, v48 row_ror:4 row_mask:0xf bank_mask:0xf
    s_nop 0
    v_add_f32_dpp v49, v49, v49 row_ror:4 row_mask:0xf bank_mask:0xf
    v_add_f32_dpp v48, v48, v48 row_ror:2 row_mask:0xf bank_mask:0xf
    s_nop 0
    v_add_f32_dpp v49, v49, v49 row_ror:2 row_mask:0xf bank_mask:0xf
    v_add_f32_dpp v48, v48, v48 row_ror:1 row_mask:0xf bank_mask:0xf
    s_nop 0
    v_add_f32_dpp v49, v49, v49 row_ror:1 row_mask:0xf bank_mask:0xf
    v_mul_f32 v48, 0xbae38e39, v48
    v_mul_f32 v49, 0x3ae38e39, v49
    v_fma_f32 v49, -v48, v48, v49
    v_add_f32 v49, 0x3727c5ac, v49
    v_rsq_f32 v49, v49
    s_nop 0
    v_mul_f32 v49, 0x3e0293ee, v49
Lskip_7:
    s_cmp_eq_u32 s3, 7
    s_cbranch_scc0 Lskip_8
    s_waitcnt vmcnt(6)
    v_readfirstlane_b32 s7, v55
    s_nop 0
    s_add_u32 s7, s7, 1
    s_and_b32 s6, s7, 0xff
    v_mov_b32 v55, 0xffffff00
    v_mov_b32 v4, s7
    v_mov_b32 v5, s67
    s_lshl_b32 s68, s4, 5
    s_add_u32 s68, s68, s5
    s_lshl_b32 s68, s68, 7
    s_add_u32 s68, s68, 4096
    s_waitcnt vmcnt(4)
    s_mov_b64 exec, 1
    buffer_store_dwordx2 v[4:5], off, s[16:19], s68 sc1
    s_mov_b64 exec, -1
Lskip_8:
    s_cmp_eq_u32 s3, 6
    s_cbranch_scc0 Lskip_9
    s_waitcnt vmcnt(9)
    v_readfirstlane_b32 s7, v55
    s_nop 0
    s_add_u32 s7, s7, 1
    s_and_b32 s6, s7, 0xff
    v_mov_b32 v55, 0xffffff00
    v_lshlrev_b32 v44, 11, v2
    v_lshl_add_u32 v44, v1, 4, v44
    s_lshl_b32 s70, s4, 15
    s_lshl_b32 s71, s66, 13
    s_add_u32 s70, s70, s71
    s_lshl_b32 s71, s73, 8
    s_add_u32 s70, s70, s71
    s_add_u32 s70, s70, 65536
    v_mov_b32 v4, 0
Lcnt_10:
    ds_read_b32 v5, v4 offset:648
    s_waitcnt lgkmcnt(0)
    v_readfirstlane_b32 s15, v5
    s_nop 0
    s_cmp_eq_u32 s15, 5
    s_cbranch_scc1 Lcntd_11
    s_sleep 1
    s_sub_u32 s8, s8, 1
    s_cbranch_scc0 Lcnt_10
    s_mov_b32 s8, 0
Lcntd_11:
    ds_read_b128 v[8:11], v51 offset:9216
    ds_read_b128 v[12:15], v51 offset:10240
    ds_read_b128 v[16:19], v51 offset:11264
    ds_read_b128 v[20:23], v51 offset:12288
    ds_read_b128 v[24:27], v51 offset:13312
    ds_read_b128 v[56:59], v51 offset:17408
    ds_read_b128 v[60:63], v51 offset:18432
    ds_read_b128 v[64:67], v51 offset:19456
    ds_read_b128 v[68:71], v51 offset:20480
    ds_read_b128 v[72:75], v51 offset:21504
    s_waitcnt lgkmcnt(8)
    v_pk_add_f32 v[8:9], v[8:9], v[12:13]
    v_pk_add_f32 v[10:11], v[10:11], v[14:15]
    s_waitcnt lgkmcnt(7)
    v_pk_add_f32 v[8:9], v[8:9], v[16:17]
    v_pk_add_f32 v[10:11], v[10:11], v[18:19]
    s_waitcnt lgkmcnt(6)
    v_pk_add_f32 v[8:9], v[8:9], v[20:21]
    v_pk_add_f32 v[10:11], v[10:11], v[22:23]
    s_waitcnt lgkmcnt(5)
    v_pk_add_f32 v[8:9], v[8:9], v[24:25]
    v_pk_add_f32 v[10:11], v[10:11], v[26:27]
    s_waitcnt lgkmcnt(3)
    v_pk_add_f32 v[56:57], v[56:57], v[60:61]
    v_pk_add_f32 v[58:59], v[58:59], v[62:63]
    s_waitcnt lgkmcnt(2)
    v_pk_add_f32 v[56:57], v[56:57], v[64:65]
    v_pk_add_f32 v[58:59], v[58:59], v[66:67]
    s_waitcnt lgkmcnt(1)
    v_pk_add_f32 v[56:57], v[56:57], v[68:69]
    v_pk_add_f32 v[58:59], v[58:59], v[70:71]
    s_waitcnt lgkmcnt(0)
    v_pk_add_f32 v[56:57], v[56:57], v[72:73]
    v_pk_add_f32 v[58:59], v[58:59], v[74:75]
    v_pk_fma_f32 v[8:9], v[56:57], v[48:49], v[8:9] op_sel_hi:[1,0,1]
    v_pk_fma_f32 v[10:11], v[58:59], v[48:49], v[10:11] op_sel_hi:[1,0,1]
    v_pk_mul_f32 v[8:9], v[8:9], v[48:49] op_sel:[0,1] op_sel_hi:[1,1]
    v_pk_mul_f32 v[10:11], v[10:11], v[48:49] op_sel:[0,1] op_sel_hi:[1,1]
    v_and_or_b32 v8, v8, v55, s6
    buffer_store_dwordx4 v[8:11], v44, s[16:19], s70 offen sc1
Lskip_9:
    s_setprio 0
    s_cmp_lt_u32 s12, 9
    s_cbranch_scc0 Lskip_12
    s_cmp_eq_u32 s3, 6
    s_cbranch_scc0 Lskip_13
    s_mul_i32 s68, s4, 1152
    s_lshl_b32 s69, s12, 7
    s_add_u32 s68, s68, s69
    s_add_u32 s28, s46, s68
    s_addc_u32 s29, s47, 0
    s_sub_u32 s30, 9216, s68
    s_mov_b32 s31, 0x20000
    v_lshlrev_b32 v44, 3, v1
    buffer_load_dwordx2 v[88:89], v44, s[28:31], 0 offen
Lskip_13:
Lskip_12:
    s_cmp_lt_u32 s13, 18
    s_cbranch_scc0 Lskip_14
    v_and_b32 v44, 7, v0
    v_lshlrev_b32 v44, 3, v44
    v_lshrrev_b32 v45, 5, v0
    v_lshl_add_u32 v44, v45, 2, v44
    s_lshl_b32 s68, s13, 6
    s_add_u32 s28, s50, s68
    s_addc_u32 s29, s51, 0
    s_sub_u32 s30, 1152, s68
    s_mov_b32 s31, 0x20000
    buffer_load_dword v73, v44, s[28:31], 0 offen
    v_bfe_u32 v45, v0, 3, 2
    v_mul_u32_u24 v45, 1152, v45
    v_add3_u32 v74, v44, v45, s68
    s_mov_b32 s28, s32
    s_mov_b32 s29, s33
    s_mov_b32 s30, 4608
    s_mov_b32 s31, 0x20000
    buffer_load_dword v72, v74, s[28:31], 0 offen
Lskip_14:
    buffer_load_dwordx4 v[192:195], v51, s[24:27], s60 offen offset:0 nt
    buffer_load_dwordx4 v[196:199], v51, s[24:27], s60 offen offset:1024 nt
    buffer_load_dwordx4 v[200:203], v51, s[24:27], s60 offen offset:2048 nt
    buffer_load_dwordx4 v[204:207], v51, s[24:27], s60 offen offset:3072 nt
    buffer_load_dwordx4 v[144:147], v50, s[20:23], s61 offen offset:0 nt
    buffer_load_dwordx4 v[148:151], v50, s[20:23], s61 offen offset:64 nt
    buffer_load_dwordx4 v[152:155], v50, s[20:23], s61 offen offset:128 nt
    buffer_load_dwordx4 v[156:159], v50, s[20:23], s61 offen offset:192 nt
    buffer_load_dwordx4 v[208:211], v51, s[24:27], s61 offen offset:0 nt
    buffer_load_dwordx4 v[212:215], v51, s[24:27], s61 offen offset:1024 nt
    buffer_load_dwordx4 v[216:219], v51, s[24:27], s61 offen offset:2048 nt
    buffer_load_dwordx4 v[220:223], v51, s[24:27], s61 offen offset:3072 nt
    s_cmp_eq_u32 s72, 1
    s_cbranch_scc0 Lskip_15
    s_lshl_b32 s15, s4, 1
    s_add_u32 s15, s15, s11
    s_mul_i32 s15, s15, 294912
    s_lshl_b32 s28, s10, 7
    s_add_u32 s15, s15, s28
    s_add_u32 s28, s40, s15
    s_addc_u32 s29, s41, 0
    s_sub_u32 s30, 4718592, s15
    s_mov_b32 s31, 0x20000
    v_mul_u32_u24 v44, 9216, v2
    v_lshl_add_u32 v44, v1, 3, v44
    s_mul_i32 s15, s3, 36864
    v_add_u32 v44, s15, v44
    s_mov_b32 s15, 0
    buffer_load_dwordx2 v[80:81], v44, s[28:31], s15 offen offset:0 nt
    buffer_load_dwordx2 v[82:83], v44, s[28:31], s15 offen offset:1152 nt
    buffer_load_dwordx2 v[84:85], v44, s[28:31], s15 offen offset:2304 nt
    buffer_load_dwordx2 v[86:87], v44, s[28:31], s15 offen offset:3456 nt
    s_mov_b32 s15, 4608
    buffer_load_dwordx2 v[88:89], v44, s[28:31], s15 offen offset:0 nt
    buffer_load_dwordx2 v[90:91], v44, s[28:31], s15 offen offset:1152 nt
    buffer_load_dwordx2 v[92:93], v44, s[28:31], s15 offen offset:2304 nt
    buffer_load_dwordx2 v[94:95], v44, s[28:31], s15 offen offset:3456 nt
Lskip_15:
    buffer_load_dwordx4 v[160:163], v50, s[20:23], s62 offen offset:0 nt
    buffer_load_dwordx4 v[164:167], v50, s[20:23], s62 offen offset:64 nt
    buffer_load_dwordx4 v[168:171], v50, s[20:23], s62 offen offset:128 nt
    buffer_load_dwordx4 v[172:175], v50, s[20:23], s62 offen offset:192 nt
    buffer_load_dwordx4 v[176:179], v50, s[20:23], s63 offen offset:0 nt
    buffer_load_dwordx4 v[180:183], v50, s[20:23], s63 offen offset:64 nt
    buffer_load_dwordx4 v[184:187], v50, s[20:23], s63 offen offset:128 nt
    buffer_load_dwordx4 v[188:191], v50, s[20:23], s63 offen offset:192 nt
    buffer_load_dwordx4 v[224:227], v51, s[24:27], s62 offen offset:0 nt
    buffer_load_dwordx4 v[228:231], v51, s[24:27], s62 offen offset:1024 nt
    buffer_load_dwordx4 v[232:235], v51, s[24:27], s62 offen offset:2048 nt
    buffer_load_dwordx4 v[236:239], v51, s[24:27], s62 offen offset:3072 nt
    s_cmp_eq_u32 s3, 0
    s_cbranch_scc0 Lskip_16
    s_lshl_b32 s68, s4, 15
    s_lshl_b32 s69, s64, 11
    s_add_u32 s68, s68, s69
    s_lshl_b32 s69, s65, 10
    s_add_u32 s68, s68, s69
    s_add_u32 s68, s68, 65536
    s_add_u32 s69, s68, 8192
    s_add_u32 s70, s68, 16384
    s_add_u32 s71, s68, 24576
    v_lshlrev_b32 v47, 4, v0
    buffer_load_dwordx4 v[8:11], v47, s[16:19], s68 offen sc1
    buffer_load_dwordx4 v[12:15], v47, s[16:19], s69 offen sc1
    buffer_load_dwordx4 v[16:19], v47, s[16:19], s70 offen sc1
    buffer_load_dwordx4 v[20:23], v47, s[16:19], s71 offen sc1
Lskip_16:
    s_cmp_eq_u32 s3, 7
    s_cbranch_scc0 Lskip_17
    v_and_b32 v8, 31, v0
    s_lshl_b32 s68, s4, 5
    v_add_u32 v8, s68, v8
    v_lshlrev_b32 v6, 7, v8
    s_mov_b32 s71, 4096
    buffer_load_dwordx2 v[4:5], v6, s[16:19], s71 offen sc1
Lskip_17:
    buffer_load_dwordx4 v[240:243], v51, s[24:27], s63 offen offset:0 nt
    buffer_load_dwordx4 v[244:247], v51, s[24:27], s63 offen offset:1024 nt
    buffer_load_dwordx4 v[248:251], v51, s[24:27], s63 offen offset:2048 nt
    buffer_load_dwordx4 v[252:255], v51, s[24:27], s63 offen offset:3072 nt
    s_cmp_lt_u32 s3, 6
    s_cbranch_scc0 Lskip_18
    s_waitcnt vmcnt(32)
    v_readfirstlane_b32 s7, v55
    s_nop 0
    s_add_u32 s7, s7, 1
    s_and_b32 s6, s7, 0xff
    v_mov_b32 v55, 0xffffff00
Lskip_18:
    v_and_b32 v54, 1, v0
    v_lshlrev_b32 v54, 8, v54
    v_lshl_add_u32 v54, v2, 4, v54
    s_lshl_b32 s15, s3, 10
    v_lshl_add_u32 v46, v0, 5, s15
    s_lshl_b32 s15, s3, 3
    v_lshl_add_u32 v3, v0, 6, s15
    s_lshl_b32 s15, s3, 2
    v_lshl_add_u32 v45, v0, 3, s15
    v_and_b32 v7, 7, v0
    s_lshl_b32 s15, s3, 6
    v_lshl_add_u32 v7, v7, 3, s15
    s_lshl_b32 s62, s65, 1
    s_add_u32 s62, s62, s3
    s_lshl_b32 s60, s62, 12
    s_lshl_b32 s15, s64, 8
    s_add_u32 s60, s60, s15
    s_lshl_b32 s15, s66, 6
    s_add_u32 s60, s60, s15
    s_add_u32 s60, s60, s14
    s_add_u32 s60, s60, 0
    s_lshl_b32 s61, s62, 9
    s_lshl_b32 s15, s64, 4
    s_add_u32 s61, s61, s15
    s_lshl_b32 s15, s66, 2
    s_add_u32 s61, s61, s15
    s_add_u32 s61, s61, s14
    s_add_u32 s61, s61, 32768
    v_lshlrev_b32 v44, 10, v2
    v_lshl_add_u32 v44, v1, 2, v44
    s_cmp_eq_u32 s3, 0
    s_cbranch_scc0 Lskip_19
    s_waitcnt vmcnt(4)
Lq0_20:
    v_xor_b32 v8, s6, v8
    v_xor_b32 v12, s6, v12
    v_xor_b32 v16, s6, v16
    v_xor_b32 v20, s6, v20
    v_or3_b32 v4, v8, v12, v16
    v_or_b32 v4, v4, v20
    v_and_b32 v4, 0xff, v4
    v_cmp_ne_u32 vcc, 0, v4
    s_cbranch_vccz Lq0d_21
    s_sub_u32 s8, s8, 1
    s_cbranch_scc1 Lq0d_21x
    buffer_load_dwordx4 v[8:11], v47, s[16:19], s68 offen sc1
    buffer_load_dwordx4 v[12:15], v47, s[16:19], s69 offen sc1
    buffer_load_dwordx4 v[16:19], v47, s[16:19], s70 offen sc1
    buffer_load_dwordx4 v[20:23], v47, s[16:19], s71 offen sc1
    s_waitcnt vmcnt(0)
    s_branch Lq0_20
Lq0d_21x:
    s_mov_b32 s8, 0
Lq0d_21:
    v_pk_add_f32 v[8:9], v[8:9], v[12:13]
    v_pk_add_f32 v[10:11], v[10:11], v[14:15]
    v_pk_add_f32 v[16:17], v[16:17], v[20:21]
    v_pk_add_f32 v[18:19], v[18:19], v[22:23]
    v_pk_add_f32 v[8:9], v[8:9], v[16:17]
    v_pk_add_f32 v[10:11], v[10:11], v[18:19]
    v_cvt_pk_bf16_f32 v8, v8, v9
    v_cvt_pk_bf16_f32 v9, v10, v11
    v_lshlrev_b32 v10, 3, v0
    ds_write_b64 v10, v[8:9] offset:0
    s_waitcnt lgkmcnt(0)
    v_mov_b32 v10, 0
    v_mov_b32 v11, 1
    ds_write_b32 v10, v11 offset:652
Lskip_19:
    s_waitcnt vmcnt(24)
    s_waitcnt vmcnt(16)
    v_perm_b32 v96, v196, v192, s58
    v_perm_b32 v97, v204, v200, s58
    v_perm_b32 v98, v212, v208, s58
    v_perm_b32 v99, v220, v216, s58
    v_perm_b32 v100, v196, v192, s59
    v_perm_b32 v101, v204, v200, s59
    v_perm_b32 v102, v212, v208, s59
    v_perm_b32 v103, v220, v216, s59
    v_perm_b32 v104, v197, v193, s58
    v_perm_b32 v105, v205, v201, s58
    v_perm_b32 v106, v213, v209, s58
    v_perm_b32 v107, v221, v217, s58
    v_perm_b32 v108, v197, v193, s59
    v_perm_b32 v109, v205, v201, s59
    v_perm_b32 v110, v213, v209, s59
    v_perm_b32 v111, v221, v217, s59
    v_perm_b32 v112, v198, v194, s58
    v_perm_b32 v113, v206, v202, s58
    v_perm_b32 v114, v214, v210, s58
    v_perm_b32 v115, v222, v218, s58
    v_perm_b32 v116, v198, v194, s59
    v_perm_b32 v117, v206, v202, s59
    v_perm_b32 v118, v214, v210, s59
    v_perm_b32 v119, v222, v218, s59
    v_perm_b32 v120, v199, v195, s58
    v_perm_b32 v121, v207, v203, s58
    v_perm_b32 v122, v215, v211, s58
    v_perm_b32 v123, v223, v219, s58
    v_perm_b32 v124, v199, v195, s59
    v_perm_b32 v125, v207, v203, s59
    v_perm_b32 v126, v215, v211, s59
    v_perm_b32 v127, v223, v219, s59
    s_cmp_eq_u32 s72, 1
    s_cbranch_scc0 Lskip_22
    s_waitcnt vmcnt(16)
    v_perm_b32 v72, v82, v80, s58
    v_perm_b32 v76, v82, v80, s59
    v_perm_b32 v73, v86, v84, s58
    v_perm_b32 v77, v86, v84, s59
    v_perm_b32 v74, v90, v88, s58
    v_perm_b32 v78, v90, v88, s59
    v_perm_b32 v75, v94, v92, s58
    v_perm_b32 v79, v94, v92, s59
    v_perm_b32 v80, v83, v81, s58
    v_perm_b32 v84, v83, v81, s59
    v_perm_b32 v81, v87, v85, s58
    v_perm_b32 v85, v87, v85, s59
    v_perm_b32 v82, v91, v89, s58
    v_perm_b32 v86, v91, v89, s59
    v_perm_b32 v83, v95, v93, s58
    v_perm_b32 v87, v95, v93, s59
Lskip_22:
    v_mov_b32 v52, 0
Lcnt_23:
    ds_read_b32 v53, v52 offset:652
    s_waitcnt lgkmcnt(0)
    v_readfirstlane_b32 s15, v53
    s_nop 0
    s_cmp_eq_u32 s15, 1
    s_cbranch_scc1 Lcntd_24
    s_sleep 4
    s_sub_u32 s8, s8, 1
    s_cbranch_scc0 Lcnt_23
    s_mov_b32 s8, 0
Lcntd_24:
    ds_read_b128 v[8:11], v54 offset:0
    ds_read_b128 v[12:15], v54 offset:64
    ds_read_b128 v[16:19], v54 offset:128
    ds_read_b128 v[20:23], v54 offset:192
    s_setprio 1
    s_waitcnt lgkmcnt(3)
    v_mfma_f32_16x16x32_bf16 v[24:27], v[128:131], v[8:11], 0
    s_waitcnt lgkmcnt(2)
    v_mfma_f32_16x16x32_bf16 v[24:27], v[132:135], v[12:15], v[24:27]
    s_waitcnt lgkmcnt(1)
    v_mfma_f32_16x16x32_bf16 v[24:27], v[136:139], v[16:19], v[24:27]
    s_waitcnt lgkmcnt(0)
    v_mfma_f32_16x16x32_bf16 v[24:27], v[140:143], v[20:23], v[24:27]
    v_mfma_f32_16x16x32_bf16 v[28:31], v[144:147], v[8:11], 0
    v_mfma_f32_16x16x32_bf16 v[28:31], v[148:151], v[12:15], v[28:31]
    v_mfma_f32_16x16x32_bf16 v[28:31], v[152:155], v[16:19], v[28:31]
    v_mfma_f32_16x16x32_bf16 v[28:31], v[156:159], v[20:23], v[28:31]
    s_waitcnt vmcnt(12)
    v_mfma_f32_16x16x32_bf16 v[32:35], v[160:163], v[8:11], 0
    v_mfma_f32_16x16x32_bf16 v[32:35], v[164:167], v[12:15], v[32:35]
    v_mfma_f32_16x16x32_bf16 v[32:35], v[168:171], v[16:19], v[32:35]
    v_mfma_f32_16x16x32_bf16 v[32:35], v[172:175], v[20:23], v[32:35]
    s_waitcnt vmcnt(8)
    v_mfma_f32_16x16x32_bf16 v[36:39], v[176:179], v[8:11], 0
    s_nop 0
    v_mov_b32_dpp v24, v28 quad_perm:[0,1,2,3] row_mask:0xf bank_mask:0x2
    v_mov_b32_dpp v25, v29 quad_perm:[0,1,2,3] row_mask:0xf bank_mask:0x2
    v_mfma_f32_16x16x32_bf16 v[36:39], v[180:183], v[12:15], v[36:39]
    v_mov_b32_dpp v26, v30 quad_perm:[0,1,2,3] row_mask:0xf bank_mask:0x2
    v_mov_b32_dpp v27, v31 quad_perm:[0,1,2,3] row_mask:0xf bank_mask:0x2
    v_mfma_f32_16x16x32_bf16 v[36:39], v[184:187], v[16:19], v[36:39]
    v_mov_b32_dpp v24, v32 quad_perm:[0,1,2,3] row_mask:0xf bank_mask:0x4
    v_mov_b32_dpp v25, v33 quad_perm:[0,1,2,3] row_mask:0xf bank_mask:0x4
    v_mfma_f32_16x16x32_bf16 v[36:39], v[188:191], v[20:23], v[36:39]
    v_mov_b32_dpp v26, v34 quad_perm:[0,1,2,3] row_mask:0xf bank_mask:0x4
    v_mov_b32_dpp v27, v35 quad_perm:[0,1,2,3] row_mask:0xf bank_mask:0x4
    s_setprio 0
    v_max3_f32 v53, v24, v25, v26
    v_max_f32 v53, v53, v27
    s_nop 1
    v_max_f32_dpp v53, v53, v53 row_ror:4 row_mask:0xf bank_mask:0xf
    s_nop 1
    v_max_f32_dpp v53, v53, v53 row_ror:8 row_mask:0xf bank_mask:0xf
    v_max3_f32 v52, v36, v37, v53
    v_max3_f32 v52, v38, v39, v52
    v_mov_b32 v54, v52
    v_mov_b32_dpp v24, v36 quad_perm:[0,1,2,3] row_mask:0xf bank_mask:0x8
    v_mov_b32_dpp v25, v37 quad_perm:[0,1,2,3] row_mask:0xf bank_mask:0x8
    v_permlane16_swap_b32 v54, v52
    v_max_f32 v52, v52, v54
    v_mov_b32 v54, v52
    v_mov_b32_dpp v26, v38 quad_perm:[0,1,2,3] row_mask:0xf bank_mask:0x8
    v_mov_b32_dpp v27, v39 quad_perm:[0,1,2,3] row_mask:0xf bank_mask:0x8
    v_permlane32_swap_b32 v54, v52
    v_max_f32 v52, v52, v54
    v_sub_f32 v48, v24, v52
    v_sub_f32 v49, v25, v52
    v_sub_f32 v50, v26, v52
    v_sub_f32 v51, v27, v52
    v_exp_f32 v48, v48
    v_exp_f32 v49, v49
    v_exp_f32 v50, v50
    v_exp_f32 v51, v51
    v_cvt_pk_bf16_f32 v40, v48, v49
    v_cvt_pk_bf16_f32 v41, v50, v51
    v_add_f32 v53, v48, v49
    v_mov_b32_dpp v42, v40 row_ror:12 row_mask:0xf bank_mask:0xf
    v_mov_b32_dpp v43, v41 row_ror:12 row_mask:0xf bank_mask:0xf
    s_nop 1
    v_mfma_f32_16x16x32_bf16 v[8:11], v[40:43], v[96:99], 0
    v_add_f32 v54, v50, v51
    v_mov_b32_dpp v48, v40 row_ror:8 row_mask:0xf bank_mask:0xf
    v_mfma_f32_16x16x32_bf16 v[12:15], v[40:43], v[100:103], 0
    v_mov_b32_dpp v49, v41 row_ror:8 row_mask:0xf bank_mask:0xf
    v_mov_b32_dpp v50, v40 row_ror:4 row_mask:0xf bank_mask:0xf
    v_mfma_f32_16x16x32_bf16 v[16:19], v[40:43], v[104:107], 0
    v_mov_b32_dpp v51, v41 row_ror:4 row_mask:0xf bank_mask:0xf
    v_add_f32 v53, v53, v54
    v_mfma_f32_16x16x32_bf16 v[20:23], v[40:43], v[108:111], 0
    s_nop 0
    v_add_f32_dpp v53, v53, v53 row_ror:4 row_mask:0xf bank_mask:0xf
    v_mfma_f32_16x16x32_bf16 v[24:27], v[40:43], v[112:115], 0
    s_nop 0
    v_add_f32_dpp v53, v53, v53 row_ror:8 row_mask:0xf bank_mask:0xf
    v_mfma_f32_16x16x32_bf16 v[28:31], v[40:43], v[116:119], 0
    v_mov_b32 v54, v53
    v_mfma_f32_16x16x32_bf16 v[32:35], v[40:43], v[120:123], 0
    s_nop 0
    v_permlane16_swap_b32 v54, v53
    v_mfma_f32_16x16x32_bf16 v[36:39], v[40:43], v[124:127], 0
    v_add_f32 v53, v53, v54
    v_mov_b32 v54, v53
    s_nop 1
    v_permlane32_swap_b32 v54, v53
    v_add_f32 v53, v53, v54
    s_waitcnt vmcnt(4)
    s_cmp_eq_u32 s3, 7
    s_cbranch_scc0 Lskip_25
    s_waitcnt vmcnt(4)
Lfl_26:
    v_cmp_ne_u32 vcc, s7, v4
    s_cbranch_vccz Lfld_27
    s_sub_u32 s8, s8, 1
    s_cbranch_scc1 Lfld_27x
    buffer_load_dwordx2 v[4:5], v6, s[16:19], s71 offen sc1
    s_waitcnt vmcnt(0)
    s_branch Lfl_26
Lfld_27x:
    s_mov_b32 s8, 0
Lfld_27:
    v_cmp_ne_u32 vcc, s67, v5
    s_nop 3
    v_mov_b32 v4, vcc_lo
    v_mov_b32 v5, 0
    ds_write_b32 v5, v4 offset:640
Lskip_25:
    s_waitcnt vmcnt(0)
    v_perm_b32 v192, v228, v224, s58
    v_perm_b32 v193, v236, v232, s58
    v_perm_b32 v194, v244, v240, s58
    v_perm_b32 v195, v252, v248, s58
    v_perm_b32 v196, v228, v224, s59
    v_perm_b32 v197, v236, v232, s59
    v_perm_b32 v198, v244, v240, s59
    v_perm_b32 v199, v252, v248, s59
    v_mfma_f32_16x16x32_bf16 v[8:11], v[48:51], v[192:195], v[8:11]
    v_perm_b32 v200, v229, v225, s58
    v_perm_b32 v201, v237, v233, s58
    v_perm_b32 v202, v245, v241, s58
    v_perm_b32 v203, v253, v249, s58
    v_mfma_f32_16x16x32_bf16 v[12:15], v[48:51], v[196:199], v[12:15]
    v_perm_b32 v204, v229, v225, s59
    v_perm_b32 v205, v237, v233, s59
    v_perm_b32 v206, v245, v241, s59
    v_perm_b32 v207, v253, v249, s59
    v_mfma_f32_16x16x32_bf16 v[16:19], v[48:51], v[200:203], v[16:19]
    v_perm_b32 v208, v230, v226, s58
    v_perm_b32 v209, v238, v234, s58
    v_perm_b32 v210, v246, v242, s58
    v_perm_b32 v211, v254, v250, s58
    v_mfma_f32_16x16x32_bf16 v[20:23], v[48:51], v[204:207], v[20:23]
    v_perm_b32 v212, v230, v226, s59
    v_perm_b32 v213, v238, v234, s59
    v_perm_b32 v214, v246, v242, s59
    v_perm_b32 v215, v254, v250, s59
    v_mfma_f32_16x16x32_bf16 v[24:27], v[48:51], v[208:211], v[24:27]
    v_perm_b32 v216, v231, v227, s58
    v_perm_b32 v217, v239, v235, s58
    v_perm_b32 v218, v247, v243, s58
    v_perm_b32 v219, v255, v251, s58
    v_mfma_f32_16x16x32_bf16 v[28:31], v[48:51], v[212:215], v[28:31]
    v_perm_b32 v220, v231, v227, s59
    v_perm_b32 v221, v239, v235, s59
    v_perm_b32 v222, v247, v243, s59
    v_perm_b32 v223, v255, v251, s59
    v_mfma_f32_16x16x32_bf16 v[32:35], v[48:51], v[216:219], v[32:35]
    s_nop 0
    v_mfma_f32_16x16x32_bf16 v[36:39], v[48:51], v[220:223], v[36:39]
    s_mov_b64 exec, 3
    ds_write_b64 v3, v[52:53] offset:512
    s_mov_b64 exec, 0xffff
    ds_write2_b64 v46, v[8:9], v[12:13] offset0:128 offset1:192
    ds_write2_b64 v46, v[16:17], v[20:21] offset0:129 offset1:193
    ds_write2_b64 v46, v[24:25], v[28:29] offset0:130 offset1:194
    s_nop 1
    ds_write2_b64 v46, v[32:33], v[36:37] offset0:131 offset1:195
    s_mov_b64 exec, -1
    s_waitcnt lgkmcnt(0)
    s_barrier
    v_mov_b32 v5, 0
    ds_read_b32 v4, v5 offset:640
    s_cmp_lt_u32 s3, 2
    s_cbranch_scc0 Lskip_28
    ds_read_b64 v[52:53], v7 offset:512
    ds_read2st64_b32 v[8:9], v45 offset0:4 offset1:6
    ds_read2st64_b32 v[10:11], v45 offset0:8 offset1:10
    ds_read2st64_b32 v[12:13], v45 offset0:12 offset1:14
    ds_read2st64_b32 v[14:15], v45 offset0:16 offset1:18
    ds_read2st64_b32 v[16:17], v45 offset0:20 offset1:22
    ds_read2st64_b32 v[18:19], v45 offset0:24 offset1:26
    ds_read2st64_b32 v[20:21], v45 offset0:28 offset1:30
    ds_read2st64_b32 v[22:23], v45 offset0:32 offset1:34
    v_lshlrev_b32 v29, 7, v0
    s_waitcnt lgkmcnt(8)
    v_max_f32_dpp v54, v52, v52 quad_perm:[1,0,3,2] row_mask:0xf bank_mask:0xf
    s_nop 1
    v_max_f32_dpp v54, v54, v54 quad_perm:[2,3,0,1] row_mask:0xf bank_mask:0xf
    s_nop 1
    v_max_f32_dpp v54, v54, v54 row_half_mirror row_mask:0xf bank_mask:0xf
    v_sub_f32 v52, v52, v54
    v_exp_f32 v52, v52
    s_nop 0
    v_mul_f32 v53, v53, v52
    v_readlane_b32 s20, v52, 0
    v_readlane_b32 s21, v52, 1
    v_add_f32_dpp v53, v53, v53 quad_perm:[1,0,3,2] row_mask:0xf bank_mask:0xf
    v_readlane_b32 s22, v52, 2
    v_readlane_b32 s23, v52, 3
    v_add_f32_dpp v53, v53, v53 quad_perm:[2,3,0,1] row_mask:0xf bank_mask:0xf
    v_readlane_b32 s24, v52, 4
    v_readlane_b32 s25, v52, 5
    v_add_f32_dpp v53, v53, v53 row_half_mirror row_mask:0xf bank_mask:0xf
    v_readlane_b32 s26, v52, 6
    v_readlane_b32 s27, v52, 7
    v_rcp_f32 v28, v53
    s_waitcnt lgkmcnt(0)
    v_readfirstlane_b32 s9, v4
    v_pk_mul_f32 v[24:25], v[8:9], s[20:21] op_sel_hi:[1,0]
    v_pk_mul_f32 v[26:27], v[10:11], s[20:21] op_sel:[0,1] op_sel_hi:[1,1]
    v_pk_fma_f32 v[24:25], v[12:13], s[22:23], v[24:25] op_sel_hi:[1,0,1]
    v_pk_fma_f32 v[26:27], v[14:15], s[22:23], v[26:27] op_sel:[0,1,0] op_sel_hi:[1,1,1]
    v_pk_fma_f32 v[24:25], v[16:17], s[24:25], v[24:25] op_sel_hi:[1,0,1]
    v_pk_fma_f32 v[26:27], v[18:19], s[24:25], v[26:27] op_sel:[0,1,0] op_sel_hi:[1,1,1]
    v_pk_fma_f32 v[24:25], v[20:21], s[26:27], v[24:25] op_sel_hi:[1,0,1]
    v_pk_fma_f32 v[26:27], v[22:23], s[26:27], v[26:27] op_sel:[0,1,0] op_sel_hi:[1,1,1]
    v_log_f32 v53, v53
    v_pk_add_f32 v[24:25], v[24:25], v[26:27]
    v_mul_f32 v24, v24, v28
    v_mul_f32 v25, v25, v28
    v_cvt_pk_bf16_f32 v24, v24, v25
    v_add_f32 v53, v53, v54
    s_cmp_lg_u32 s9, 0
    s_cbranch_scc1 Lsl_29
    buffer_store_dword v24, v44, s[16:19], s60 offen
    s_mov_b64 exec, 15
    buffer_store_dword v53, v29, s[16:19], s61 offen
Lsd_30:
    s_mov_b64 exec, -1
Lskip_28:
    s_cmp_ge_u32 s3, 2
    s_cbranch_scc0 Lskip_31
    s_waitcnt lgkmcnt(0)
    v_readfirstlane_b32 s9, v4
Lskip_31:
    s_cmp_lt_u32 s12, 9
    s_cbranch_scc0 Lskip_32
    s_barrier
Lskip_32:
    s_cmp_eq_u32 s72, 2
    s_cbranch_scc0 Lskip_33
    s_mul_i32 s15, s4, 1152
    s_lshl_b32 s28, s12, 7
    s_add_u32 s15, s15, s28
    s_add_u32 s28, s44, s15
    s_addc_u32 s29, s45, 0
    s_sub_u32 s30, 5308416, s15
    s_mov_b32 s31, 0x20000
    v_mul_u32_u24 v44, 73728, v2
    v_lshl_add_u32 v44, v1, 3, v44
    s_mul_i32 s15, s3, 884736
    v_add_u32 v44, s15, v44
    s_mov_b32 s15, 0
    buffer_load_dwordx2 v[80:81], v44, s[28:31], s15 offen nt
    s_mov_b32 s15, 9216
    buffer_load_dwordx2 v[82:83], v44, s[28:31], s15 offen nt
    s_mov_b32 s15, 18432
    buffer_load_dwordx2 v[84:85], v44, s[28:31], s15 offen nt
    s_mov_b32 s15, 27648
    buffer_load_dwordx2 v[86:87], v44, s[28:31], s15 offen nt
    s_mov_b32 s15, 36864
    buffer_load_dwordx2 v[88:89], v44, s[28:31], s15 offen nt
    s_mov_b32 s15, 46080
    buffer_load_dwordx2 v[90:91], v44, s[28:31], s15 offen nt
    s_mov_b32 s15, 55296
    buffer_load_dwordx2 v[92:93], v44, s[28:31], s15 offen nt
    s_mov_b32 s15, 64512
    buffer_load_dwordx2 v[94:95], v44, s[28:31], s15 offen nt
    s_mov_b32 s15, 294912
    buffer_load_dwordx2 v[232:233], v44, s[28:31], s15 offen nt
    s_mov_b32 s15, 304128
    buffer_load_dwordx2 v[234:235], v44, s[28:31], s15 offen nt
    s_mov_b32 s15, 313344
    buffer_load_dwordx2 v[236:237], v44, s[28:31], s15 offen nt
    s_mov_b32 s15, 322560
    buffer_load_dwordx2 v[238:239], v44, s[28:31], s15 offen nt
    s_mov_b32 s15, 331776
    buffer_load_dwordx2 v[240:241], v44, s[28:31], s15 offen nt
    s_mov_b32 s15, 340992
    buffer_load_dwordx2 v[242:243], v44, s[28:31], s15 offen nt
    s_mov_b32 s15, 350208
    buffer_load_dwordx2 v[244:245], v44, s[28:31], s15 offen nt
    s_mov_b32 s15, 359424
    buffer_load_dwordx2 v[246:247], v44, s[28:31], s15 offen nt
    s_mov_b32 s15, 589824
    buffer_load_dwordx2 v[24:25], v44, s[28:31], s15 offen nt
    s_mov_b32 s15, 599040
    buffer_load_dwordx2 v[26:27], v44, s[28:31], s15 offen nt
    s_mov_b32 s15, 608256
    buffer_load_dwordx2 v[28:29], v44, s[28:31], s15 offen nt
    s_mov_b32 s15, 617472
    buffer_load_dwordx2 v[30:31], v44, s[28:31], s15 offen nt
    s_mov_b32 s15, 626688
    buffer_load_dwordx2 v[32:33], v44, s[28:31], s15 offen nt
    s_mov_b32 s15, 635904
    buffer_load_dwordx2 v[34:35], v44, s[28:31], s15 offen nt
    s_mov_b32 s15, 645120
    buffer_load_dwordx2 v[36:37], v44, s[28:31], s15 offen nt
    s_mov_b32 s15, 654336
    buffer_load_dwordx2 v[38:39], v44, s[28:31], s15 offen nt
    s_waitcnt vmcnt(0)
    v_perm_b32 v72, v82, v80, s58
    v_perm_b32 v76, v82, v80, s59
    v_perm_b32 v73, v86, v84, s58
    v_perm_b32 v77, v86, v84, s59
    v_perm_b32 v74, v90, v88, s58
    v_perm_b32 v78, v90, v88, s59
    v_perm_b32 v75, v94, v92, s58
    v_perm_b32 v79, v94, v92, s59
    v_perm_b32 v80, v83, v81, s58
    v_perm_b32 v84, v83, v81, s59
    v_perm_b32 v81, v87, v85, s58
    v_perm_b32 v85, v87, v85, s59
    v_perm_b32 v82, v91, v89, s58
    v_perm_b32 v86, v91, v89, s59
    v_perm_b32 v83, v95, v93, s58
    v_perm_b32 v87, v95, v93, s59
    v_perm_b32 v224, v234, v232, s58
    v_perm_b32 v228, v234, v232, s59
    v_perm_b32 v225, v238, v236, s58
    v_perm_b32 v229, v238, v236, s59
    v_perm_b32 v226, v242, v240, s58
    v_perm_b32 v230, v242, v240, s59
    v_perm_b32 v227, v246, v244, s58
    v_perm_b32 v231, v246, v244, s59
    v_perm_b32 v232, v235, v233, s58
    v_perm_b32 v236, v235, v233, s59
    v_perm_b32 v233, v239, v237, s58
    v_perm_b32 v237, v239, v237, s59
    v_perm_b32 v234, v243, v241, s58
    v_perm_b32 v238, v243, v241, s59
    v_perm_b32 v235, v247, v245, s58
    v_perm_b32 v239, v247, v245, s59
    v_perm_b32 v240, v26, v24, s58
    v_perm_b32 v244, v26, v24, s59
    v_perm_b32 v241, v30, v28, s58
    v_perm_b32 v245, v30, v28, s59
    v_perm_b32 v242, v34, v32, s58
    v_perm_b32 v246, v34, v32, s59
    v_perm_b32 v243, v38, v36, s58
    v_perm_b32 v247, v38, v36, s59
    v_perm_b32 v248, v27, v25, s58
    v_perm_b32 v252, v27, v25, s59
    v_perm_b32 v249, v31, v29, s58
    v_perm_b32 v253, v31, v29, s59
    v_perm_b32 v250, v35, v33, s58
    v_perm_b32 v254, v35, v33, s59
    v_perm_b32 v251, v39, v37, s58
    v_perm_b32 v255, v39, v37, s59
    v_mov_b32 v12, 0x3f803f80
    v_mov_b32 v13, 0x3f803f80
    v_mov_b32 v14, 0x3f803f80
    v_mov_b32 v15, 0x3f803f80
    s_nop 1
    v_mfma_f32_16x16x32_bf16 v[24:27], v[12:15], v[72:75], 0
    v_mfma_f32_16x16x32_bf16 v[28:31], v[12:15], v[76:79], 0
    v_mfma_f32_16x16x32_bf16 v[32:35], v[12:15], v[80:83], 0
    v_mfma_f32_16x16x32_bf16 v[36:39], v[12:15], v[84:87], 0
    v_mfma_f32_16x16x32_bf16 v[24:27], v[12:15], v[224:227], v[24:27]
    v_mfma_f32_16x16x32_bf16 v[28:31], v[12:15], v[228:231], v[28:31]
    v_mfma_f32_16x16x32_bf16 v[32:35], v[12:15], v[232:235], v[32:35]
    v_mfma_f32_16x16x32_bf16 v[36:39], v[12:15], v[236:239], v[36:39]
    v_mfma_f32_16x16x32_bf16 v[24:27], v[12:15], v[240:243], v[24:27]
    v_mfma_f32_16x16x32_bf16 v[28:31], v[12:15], v[244:247], v[28:31]
    v_mfma_f32_16x16x32_bf16 v[32:35], v[12:15], v[248:251], v[32:35]
    v_mfma_f32_16x16x32_bf16 v[36:39], v[12:15], v[252:255], v[36:39]
    s_lshl_b32 s15, s3, 10
    v_lshl_add_u32 v47, v0, 4, s15
    v_add_u32 v47, 17408, v47
    s_nop 2
    ds_write2_b32 v47, v24, v28 offset0:0 offset1:1
    s_nop 0
    ds_write2_b32 v47, v32, v36 offset0:2 offset1:3
Lskip_33:
    s_cmp_lt_u32 s5, 18
    s_cbranch_scc0 Lskip_34
    s_lshr_b32 s68, s3, 2
    s_lshl_b32 s69, s11, 1
    s_add_u32 s68, s68, s69
    s_and_b32 s69, s3, 3
    s_lshl_b32 s70, s68, 12
    s_lshl_b32 s69, s69, 10
    s_add_u32 s70, s70, s69
    s_add_u32 s70, s70, s14
    s_add_u32 s70, s70, 0
    s_lshl_b32 s71, s68, 9
    s_lshr_b32 s69, s69, 3
    s_add_u32 s71, s71, s69
    s_add_u32 s71, s71, s14
    s_add_u32 s71, s71, 32768
    v_lshlrev_b32 v42, 6, v1
    v_lshl_add_u32 v42, v2, 4, v42
    v_lshlrev_b32 v45, 4, v2
    s_lshl_b32 s15, s3, 10
    v_lshl_add_u32 v46, v0, 4, s15
    v_lshrrev_b32 v44, 3, v1
    v_lshlrev_b32 v44, 13, v44
    v_lshl_add_u32 v44, v2, 7, v44
    v_and_b32 v43, 7, v1
    v_lshl_add_u32 v44, v43, 4, v44
    s_lshl_b32 s68, s10, 14
    s_lshl_b32 s69, s4, 10
    s_add_u32 s68, s68, s69
    s_lshl_b32 s69, s11, 9
    s_add_u32 s68, s68, s69
    s_add_u32 s68, s68, 589824
Lpoll_35:
    buffer_load_dwordx4 v[8:11], v42, s[16:19], s70 offen sc1
    buffer_load_dwordx4 v[16:19], v45, s[16:19], s71 offen sc1
    s_waitcnt vmcnt(0)
    v_max3_u32 v47, v8, v9, v10
    v_max3_u32 v47, v47, v11, v16
    v_max3_u32 v47, v47, v17, v18
    v_max_u32 v47, v47, v19
    v_cmp_eq_u32 vcc, -1, v47
    s_cbranch_vccz Lpd_36
    s_sub_u32 s8, s8, 1
    s_cbranch_scc0 Lpoll_35
    s_mov_b32 s8, 0
Lpd_36:
    v_mfma_f32_16x16x32_bf16 v[24:27], v[8:11], v[72:75], 0
    v_mfma_f32_16x16x32_bf16 v[28:31], v[8:11], v[76:79], 0
    v_mfma_f32_16x16x32_bf16 v[32:35], v[8:11], v[80:83], 0
    v_mfma_f32_16x16x32_bf16 v[36:39], v[8:11], v[84:87], 0
    v_max3_f32 v20, v16, v17, v18
    v_max_f32 v20, v20, v19
    v_sub_f32 v16, v16, v20
    v_sub_f32 v17, v17, v20
    v_sub_f32 v18, v18, v20
    v_sub_f32 v19, v19, v20
    v_exp_f32 v16, v16
    v_exp_f32 v17, v17
    v_exp_f32 v18, v18
    v_exp_f32 v19, v19
    v_add_f32 v20, v16, v17
    v_add_f32 v21, v18, v19
    v_add_f32 v20, v20, v21
    v_rcp_f32 v20, v20
    s_nop 0
    v_pk_mul_f32 v[16:17], v[16:17], v[20:21] op_sel_hi:[1,0]
    v_pk_mul_f32 v[18:19], v[18:19], v[20:21] op_sel_hi:[1,0]
    v_pk_mul_f32 v[24:25], v[24:25], v[16:17]
    v_pk_mul_f32 v[28:29], v[28:29], v[16:17]
    v_pk_mul_f32 v[32:33], v[32:33], v[16:17]
    v_pk_mul_f32 v[36:37], v[36:37], v[16:17]
    v_pk_fma_f32 v[24:25], v[26:27], v[18:19], v[24:25]
    v_pk_fma_f32 v[28:29], v[30:31], v[18:19], v[28:29]
    v_pk_fma_f32 v[32:33], v[34:35], v[18:19], v[32:33]
    v_pk_fma_f32 v[36:37], v[38:39], v[18:19], v[36:37]
    v_add_f32 v12, v24, v25
    v_add_f32 v13, v28, v29
    v_add_f32 v14, v32, v33
    v_add_f32 v15, v36, v37
    ds_write_b128 v46, v[12:15] offset:9216
    s_waitcnt lgkmcnt(0)
    s_barrier
    s_cmp_eq_u32 s3, 0
    s_cbranch_scc0 Lskip_37
    v_lshlrev_b32 v46, 4, v0
    ds_read_b128 v[8:11], v46 offset:9216
    ds_read_b128 v[12:15], v46 offset:10240
    ds_read_b128 v[16:19], v46 offset:11264
    ds_read_b128 v[20:23], v46 offset:12288
    ds_read_b128 v[24:27], v46 offset:13312
    ds_read_b128 v[28:31], v46 offset:14336
    ds_read_b128 v[32:35], v46 offset:15360
    ds_read_b128 v[36:39], v46 offset:16384
    s_waitcnt lgkmcnt(6)
    v_pk_add_f32 v[8:9], v[8:9], v[12:13]
    v_pk_add_f32 v[10:11], v[10:11], v[14:15]
    s_waitcnt lgkmcnt(5)
    v_pk_add_f32 v[8:9], v[8:9], v[16:17]
    v_pk_add_f32 v[10:11], v[10:11], v[18:19]
    s_waitcnt lgkmcnt(4)
    v_pk_add_f32 v[8:9], v[8:9], v[20:21]
    v_pk_add_f32 v[10:11], v[10:11], v[22:23]
    s_waitcnt lgkmcnt(3)
    v_pk_add_f32 v[8:9], v[8:9], v[24:25]
    v_pk_add_f32 v[10:11], v[10:11], v[26:27]
    s_waitcnt lgkmcnt(2)
    v_pk_add_f32 v[8:9], v[8:9], v[28:29]
    v_pk_add_f32 v[10:11], v[10:11], v[30:31]
    s_waitcnt lgkmcnt(1)
    v_pk_add_f32 v[8:9], v[8:9], v[32:33]
    v_pk_add_f32 v[10:11], v[10:11], v[34:35]
    s_waitcnt lgkmcnt(0)
    v_pk_add_f32 v[8:9], v[8:9], v[36:37]
    v_pk_add_f32 v[10:11], v[10:11], v[38:39]
    v_and_or_b32 v8, v8, v55, s6
    buffer_store_dwordx4 v[8:11], v44, s[16:19], s68 offen sc1
Lskip_37:
    s_lshl_b32 s15, s4, 1
    s_add_u32 s15, s15, s11
    s_mul_i32 s15, s15, 331776
    s_lshl_b32 s28, s10, 7
    s_add_u32 s15, s15, s28
    s_add_u32 s28, s48, s15
    s_addc_u32 s29, s49, 0
    s_sub_u32 s30, 5308416, s15
    s_mov_b32 s31, 0x20000
    v_mul_u32_u24 v43, 9216, v2
    v_lshl_add_u32 v43, v1, 3, v43
    s_mul_i32 s15, s3, 36864
    v_add_u32 v43, s15, v43
    s_mov_b32 s15, 0
    buffer_load_dwordx2 v[232:233], v43, s[28:31], s15 offen offset:0 nt
    buffer_load_dwordx2 v[234:235], v43, s[28:31], s15 offen offset:1152 nt
    buffer_load_dwordx2 v[236:237], v43, s[28:31], s15 offen offset:2304 nt
    buffer_load_dwordx2 v[238:239], v43, s[28:31], s15 offen offset:3456 nt
    s_mov_b32 s15, 4608
    buffer_load_dwordx2 v[240:241], v43, s[28:31], s15 offen offset:0 nt
    buffer_load_dwordx2 v[242:243], v43, s[28:31], s15 offen offset:1152 nt
    buffer_load_dwordx2 v[244:245], v43, s[28:31], s15 offen offset:2304 nt
    buffer_load_dwordx2 v[246:247], v43, s[28:31], s15 offen offset:3456 nt
    s_cmp_eq_u32 s3, 7
    s_cbranch_scc0 Lskip_38
    s_mov_b32 s15, 36864
    buffer_load_dwordx2 v[24:25], v43, s[28:31], s15 offen offset:0 nt
    buffer_load_dwordx2 v[26:27], v43, s[28:31], s15 offen offset:1152 nt
    buffer_load_dwordx2 v[28:29], v43, s[28:31], s15 offen offset:2304 nt
    buffer_load_dwordx2 v[30:31], v43, s[28:31], s15 offen offset:3456 nt
    s_mov_b32 s15, 41472
    buffer_load_dwordx2 v[32:33], v43, s[28:31], s15 offen offset:0 nt
    buffer_load_dwordx2 v[34:35], v43, s[28:31], s15 offen offset:1152 nt
    buffer_load_dwordx2 v[36:37], v43, s[28:31], s15 offen offset:2304 nt
    buffer_load_dwordx2 v[38:39], v43, s[28:31], s15 offen offset:3456 nt
Lskip_38:
    s_waitcnt vmcnt(0)
    v_perm_b32 v224, v234, v232, s58
    v_perm_b32 v228, v234, v232, s59
    v_perm_b32 v225, v238, v236, s58
    v_perm_b32 v229, v238, v236, s59
    v_perm_b32 v226, v242, v240, s58
    v_perm_b32 v230, v242, v240, s59
    v_perm_b32 v227, v246, v244, s58
    v_perm_b32 v231, v246, v244, s59
    v_perm_b32 v232, v235, v233, s58
    v_perm_b32 v236, v235, v233, s59
    v_perm_b32 v233, v239, v237, s58
    v_perm_b32 v237, v239, v237, s59
    v_perm_b32 v234, v243, v241, s58
    v_perm_b32 v238, v243, v241, s59
    v_perm_b32 v235, v247, v245, s58
    v_perm_b32 v239, v247, v245, s59
    s_cmp_eq_u32 s3, 7
    s_cbranch_scc0 Lskip_39
    v_perm_b32 v240, v26, v24, s58
    v_perm_b32 v244, v26, v24, s59
    v_perm_b32 v241, v30, v28, s58
    v_perm_b32 v245, v30, v28, s59
    v_perm_b32 v242, v34, v32, s58
    v_perm_b32 v246, v34, v32, s59
    v_perm_b32 v243, v38, v36, s58
    v_perm_b32 v247, v38, v36, s59
    v_perm_b32 v248, v27, v25, s58
    v_perm_b32 v252, v27, v25, s59
    v_perm_b32 v249, v31, v29, s58
    v_perm_b32 v253, v31, v29, s59
    v_perm_b32 v250, v35, v33, s58
    v_perm_b32 v254, v35, v33, s59
    v_perm_b32 v251, v39, v37, s58
    v_perm_b32 v255, v39, v37, s59
Lskip_39:
Lskip_34:
    s_cmp_lt_u32 s13, 18
    s_cbranch_scc0 Lskip_40
    s_lshl_b32 s68, s13, 13
    s_add_u32 s68, s68, 589824
    s_add_u32 s71, s68, 4096
    v_lshlrev_b32 v44, 4, v0
    s_add_u32 s69, s14, 36864
    s_lshl_b32 s70, s13, 3
    s_add_u32 s70, s70, s14
    s_add_u32 s70, s70, 60416
    v_lshlrev_b32 v45, 5, v0
    v_lshlrev_b32 v40, 16, v72
    v_and_b32 v41, 0xffff0000, v72
    v_lshlrev_b32 v6, 9, v2
    v_lshl_add_u32 v6, v1, 2, v6
    s_add_u32 s15, s14, 32768
Lpoll_41:
    buffer_load_dword v4, v6, s[16:19], s15 offen sc1
    s_waitcnt vmcnt(0)
    v_max_u32 v5, v4, v4
    v_cmp_eq_u32 vcc, -1, v5
    s_cbranch_vccz Lpd_42
    s_sub_u32 s8, s8, 1
    s_cbranch_scc0 Lpoll_41
    s_mov_b32 s8, 0
Lpd_42:
    s_sleep 4
Lpoll_43:
    buffer_load_dwordx4 v[8:11], v44, s[16:19], s68 offen offset:0 sc1
    buffer_load_dwordx4 v[12:15], v44, s[16:19], s68 offen offset:1024 sc1
    buffer_load_dwordx4 v[16:19], v44, s[16:19], s68 offen offset:2048 sc1
    buffer_load_dwordx4 v[20:23], v44, s[16:19], s68 offen offset:3072 sc1
    buffer_load_dwordx4 v[24:27], v44, s[16:19], s71 offen offset:0 sc1
    buffer_load_dwordx4 v[28:31], v44, s[16:19], s71 offen offset:1024 sc1
    buffer_load_dwordx4 v[32:35], v44, s[16:19], s71 offen offset:2048 sc1
    buffer_load_dwordx4 v[36:39], v44, s[16:19], s71 offen offset:3072 sc1
    s_waitcnt vmcnt(0)
    v_xor_b32 v8, s6, v8
    v_xor_b32 v12, s6, v12
    v_xor_b32 v16, s6, v16
    v_xor_b32 v20, s6, v20
    v_xor_b32 v24, s6, v24
    v_xor_b32 v28, s6, v28
    v_xor_b32 v32, s6, v32
    v_xor_b32 v36, s6, v36
    v_or3_b32 v46, v8, v12, v16
    v_or3_b32 v46, v46, v20, v24
    v_or3_b32 v46, v46, v28, v32
    v_or_b32 v46, v46, v36
    v_and_b32 v46, 0xff, v46
    v_cmp_ne_u32 vcc, 0, v46
    s_cbranch_vccz Lpd_44
    s_sub_u32 s8, s8, 1
    s_cbranch_scc0 Lpoll_43
    s_mov_b32 s8, 0
Lpd_44:
    v_pk_add_f32 v[56:57], v[8:9], v[12:13]
    v_pk_add_f32 v[58:59], v[10:11], v[14:15]
    v_pk_add_f32 v[60:61], v[16:17], v[20:21]
    v_pk_add_f32 v[62:63], v[18:19], v[22:23]
    v_pk_add_f32 v[64:65], v[24:25], v[28:29]
    v_pk_add_f32 v[66:67], v[26:27], v[30:31]
    v_pk_add_f32 v[68:69], v[32:33], v[36:37]
    v_pk_add_f32 v[70:71], v[34:35], v[38:39]
    v_pk_add_f32 v[56:57], v[56:57], v[60:61]
    v_pk_add_f32 v[58:59], v[58:59], v[62:63]
    v_pk_add_f32 v[64:65], v[64:65], v[68:69]
    v_pk_add_f32 v[66:67], v[66:67], v[70:71]
    v_pk_add_f32 v[56:57], v[56:57], v[64:65]
    v_pk_add_f32 v[58:59], v[58:59], v[66:67]
    s_nop 1
    v_permlane32_swap_b32 v56, v58
    v_permlane32_swap_b32 v57, v59
    v_add_f32 v56, v56, v58
    v_add_f32 v57, v57, v59
    v_cvt_pk_bf16_f32 v56, v56, v57
    v_and_b32 v57, 0xffff0000, v56
    v_lshlrev_b32 v56, 16, v56
    v_add_f32 v56, v56, v40
    v_add_f32 v57, v57, v41
    v_cvt_pk_bf16_f32 v72, v56, v57
    s_cmp_lg_u32 s9, 0
    s_cbranch_scc1 Lsl_45
    buffer_store_dword v72, v74, s[16:19], s69 offen
Lsd_46:
    v_lshlrev_b32 v56, 16, v72
    v_and_b32 v57, 0xffff0000, v72
    v_add_f32 v58, v56, v57
    v_mul_f32 v59, v56, v56
    v_fmac_f32 v59, v57, v57
    v_add_f32_dpp v58, v58, v58 quad_perm:[1,0,3,2] row_mask:0xf bank_mask:0xf
    s_nop 0
    v_add_f32_dpp v59, v59, v59 quad_perm:[1,0,3,2] row_mask:0xf bank_mask:0xf
    v_add_f32_dpp v58, v58, v58 quad_perm:[2,3,0,1] row_mask:0xf bank_mask:0xf
    s_nop 0
    v_add_f32_dpp v59, v59, v59 quad_perm:[2,3,0,1] row_mask:0xf bank_mask:0xf
    v_add_f32_dpp v58, v58, v58 row_half_mirror row_mask:0xf bank_mask:0xf
    s_nop 0
    v_add_f32_dpp v59, v59, v59 row_half_mirror row_mask:0xf bank_mask:0xf
    v_mov_b32 v60, v58
    v_mov_b32 v61, v59
    s_nop 0
    v_permlane32_swap_b32 v60, v58
    v_permlane32_swap_b32 v61, v59
    v_add_f32 v58, v58, v60
    v_add_f32 v59, v59, v61
    s_mov_b32 exec_lo, 0x1010101
    s_mov_b32 exec_hi, 0x0
    s_cmp_lg_u32 s9, 0
    s_cbranch_scc1 Lsl_47
    buffer_store_dwordx2 v[58:59], v45, s[16:19], s70 offen
Lsd_48:
    s_mov_b64 exec, -1
    s_cmp_lt_u32 s12, 9
    s_cbranch_scc0 Lskip_49
    s_barrier
Lskip_49:
Lskip_40:
    s_cmp_lt_u32 s12, 9
    s_cbranch_scc0 Lskip_50
    s_cmp_lg_u32 s3, 7
    s_cbranch_scc0 Lskip_51
    s_barrier
Lskip_51:
    s_cmp_lt_u32 s3, 6
    s_cbranch_scc0 Lskip_52
    s_lshl_b32 s15, s3, 10
    v_lshl_add_u32 v45, v0, 4, s15
    v_lshrrev_b32 v46, 2, v1
    v_mul_u32_u24 v46, 1152, v46
    v_lshl_add_u32 v46, v2, 4, v46
    v_add_u32 v45, 9216, v45
    s_mul_i32 s15, s3, 192
    s_add_u32 s15, s15, s14
    s_add_u32 s15, s15, 36864
Lpoll_53:
    buffer_load_dwordx4 v[8:11], v46, s[16:19], s15 offen offset:0 sc1
    buffer_load_dwordx4 v[12:15], v46, s[16:19], s15 offen offset:64 sc1
    buffer_load_dwordx4 v[16:19], v46, s[16:19], s15 offen offset:128 sc1
    s_waitcnt vmcnt(0)
    v_max3_u32 v47, v8, v9, v10
    v_max3_u32 v47, v47, v11, v12
    v_max3_u32 v47, v47, v13, v14
    v_max3_u32 v47, v47, v15, v16
    v_max3_u32 v47, v47, v17, v18
    v_max_u32 v47, v47, v19
    v_cmp_eq_u32 vcc, -1, v47
    s_cbranch_vccz Lpd_54
    s_sub_u32 s8, s8, 1
    s_cbranch_scc0 Lpoll_53
    s_mov_b32 s8, 0
Lpd_54:
    v_mfma_f32_16x16x32_bf16 v[24:27], v[8:11], v[72:75], 0
    v_mfma_f32_16x16x32_bf16 v[28:31], v[8:11], v[76:79], 0
    v_mfma_f32_16x16x32_bf16 v[32:35], v[8:11], v[80:83], 0
    v_mfma_f32_16x16x32_bf16 v[36:39], v[8:11], v[84:87], 0
    v_mfma_f32_16x16x32_bf16 v[24:27], v[12:15], v[224:227], v[24:27]
    v_mfma_f32_16x16x32_bf16 v[28:31], v[12:15], v[228:231], v[28:31]
    v_mfma_f32_16x16x32_bf16 v[32:35], v[12:15], v[232:235], v[32:35]
    v_mfma_f32_16x16x32_bf16 v[36:39], v[12:15], v[236:239], v[36:39]
    v_mfma_f32_16x16x32_bf16 v[24:27], v[16:19], v[240:243], v[24:27]
    v_mfma_f32_16x16x32_bf16 v[28:31], v[16:19], v[244:247], v[28:31]
    v_mfma_f32_16x16x32_bf16 v[32:35], v[16:19], v[248:251], v[32:35]
    v_mfma_f32_16x16x32_bf16 v[36:39], v[16:19], v[252:255], v[36:39]
    s_nop 5
    ds_write2_b32 v45, v24, v28 offset0:0 offset1:1
    s_nop 0
    ds_write2_b32 v45, v32, v36 offset0:2 offset1:3
    s_waitcnt lgkmcnt(0)
    s_barrier
Lskip_52:
    s_cmp_eq_u32 s3, 7
    s_cbranch_scc0 Lskip_55
    s_barrier
Lskip_55:
    s_cmp_eq_u32 s3, 6
    s_cbranch_scc0 Lskip_56
    v_mul_u32_u24 v45, 1152, v2
    v_lshl_add_u32 v45, v1, 3, v45
    s_lshl_b32 s69, s12, 7
    s_add_u32 s69, s69, s14
    s_add_u32 s69, s69, 50688
    s_waitcnt vmcnt(0)
    v_and_b32 v91, 0xffff0000, v89
    v_lshlrev_b32 v90, 16, v89
    v_and_b32 v89, 0xffff0000, v88
    v_lshlrev_b32 v88, 16, v88
    s_mov_b32 s70, 0xbdd2d3e8
    v_mov_b32 v50, 0xc0135761
    v_mov_b32 v52, s70
    v_mov_b32 v53, 1.0
    v_lshlrev_b32 v46, 4, v0
    v_lshlrev_b32 v44, 8, v2
    v_lshl_add_u32 v44, v1, 4, v44
    s_add_u32 s68, s14, 60416
    v_mov_b32 v8, 0
    v_mov_b32 v9, 0
    v_mov_b32 v10, 0
    v_mov_b32 v11, 0
    s_mov_b32 exec_lo, 0x1ff01ff
    s_mov_b32 exec_hi, 0x1ff01ff
Lpoll_57:
    buffer_load_dwordx4 v[8:11], v44, s[16:19], s68 offen sc1
    s_waitcnt vmcnt(0)
    v_max3_u32 v47, v8, v9, v10
    v_max_u32 v47, v47, v11
    v_cmp_eq_u32 vcc, -1, v47
    s_cbranch_vccz Lpd_58
    s_sub_u32 s8, s8, 1
    s_cbranch_scc0 Lpoll_57
    s_mov_b32 s8, 0
Lpd_58:
    s_mov_b64 exec, -1
    v_add_f32 v48, v8, v10
    v_add_f32 v49, v9, v11
    s_nop 0
    v_add_f32_dpp v48, v48, v48 row_ror:8 row_mask:0xf bank_mask:0xf
    v_add_f32_dpp v49, v49, v49 row_ror:8 row_mask:0xf bank_mask:0xf
    s_nop 0
    v_add_f32_dpp v48, v48, v48 row_ror:4 row_mask:0xf bank_mask:0xf
    v_add_f32_dpp v49, v49, v49 row_ror:4 row_mask:0xf bank_mask:0xf
    s_nop 0
    v_add_f32_dpp v48, v48, v48 row_ror:2 row_mask:0xf bank_mask:0xf
    v_add_f32_dpp v49, v49, v49 row_ror:2 row_mask:0xf bank_mask:0xf
    s_nop 0
    v_add_f32_dpp v48, v48, v48 row_ror:1 row_mask:0xf bank_mask:0xf
    v_add_f32_dpp v49, v49, v49 row_ror:1 row_mask:0xf bank_mask:0xf
    v_mul_f32 v48, 0xbae38e39, v48
    v_mul_f32 v49, 0x3ae38e39, v49
    v_fma_f32 v49, -v48, v48, v49
    v_add_f32 v49, 0x3727c5ac, v49
    v_rsq_f32 v49, v49
    s_barrier
    ds_read_b128 v[8:11], v46 offset:9216
    ds_read_b128 v[12:15], v46 offset:10240
    ds_read_b128 v[16:19], v46 offset:11264
    ds_read_b128 v[20:23], v46 offset:12288
    ds_read_b128 v[24:27], v46 offset:13312
    ds_read_b128 v[28:31], v46 offset:14336
    ds_read_b128 v[60:63], v46 offset:17408
    ds_read_b128 v[64:67], v46 offset:18432
    ds_read_b128 v[68:71], v46 offset:19456
    ds_read_b128 v[72:75], v46 offset:20480
    ds_read_b128 v[76:79], v46 offset:21504
    ds_read_b128 v[80:83], v46 offset:22528
    s_waitcnt lgkmcnt(10)
    v_pk_add_f32 v[8:9], v[8:9], v[12:13]
    v_pk_add_f32 v[10:11], v[10:11], v[14:15]
    s_waitcnt lgkmcnt(9)
    v_pk_add_f32 v[8:9], v[8:9], v[16:17]
    v_pk_add_f32 v[10:11], v[10:11], v[18:19]
    s_waitcnt lgkmcnt(8)
    v_pk_add_f32 v[8:9], v[8:9], v[20:21]
    v_pk_add_f32 v[10:11], v[10:11], v[22:23]
    s_waitcnt lgkmcnt(7)
    v_pk_add_f32 v[8:9], v[8:9], v[24:25]
    v_pk_add_f32 v[10:11], v[10:11], v[26:27]
    s_waitcnt lgkmcnt(6)
    v_pk_add_f32 v[8:9], v[8:9], v[28:29]
    v_pk_add_f32 v[10:11], v[10:11], v[30:31]
    s_waitcnt lgkmcnt(4)
    v_pk_add_f32 v[60:61], v[60:61], v[64:65]
    v_pk_add_f32 v[62:63], v[62:63], v[66:67]
    s_waitcnt lgkmcnt(3)
    v_pk_add_f32 v[60:61], v[60:61], v[68:69]
    v_pk_add_f32 v[62:63], v[62:63], v[70:71]
    s_waitcnt lgkmcnt(2)
    v_pk_add_f32 v[60:61], v[60:61], v[72:73]
    v_pk_add_f32 v[62:63], v[62:63], v[74:75]
    s_waitcnt lgkmcnt(1)
    v_pk_add_f32 v[60:61], v[60:61], v[76:77]
    v_pk_add_f32 v[62:63], v[62:63], v[78:79]
    s_waitcnt lgkmcnt(0)
    v_pk_add_f32 v[60:61], v[60:61], v[80:81]
    v_pk_add_f32 v[62:63], v[62:63], v[82:83]
    v_pk_fma_f32 v[8:9], v[60:61], v[48:49], v[8:9] op_sel_hi:[1,0,1]
    v_pk_fma_f32 v[10:11], v[62:63], v[48:49], v[10:11] op_sel_hi:[1,0,1]
    v_pk_fma_f32 v[8:9], v[8:9], v[48:49], v[88:89] op_sel:[0,1,0] op_sel_hi:[1,1,1]
    v_pk_fma_f32 v[10:11], v[10:11], v[48:49], v[90:91] op_sel:[0,1,0] op_sel_hi:[1,1,1]
    v_pk_mul_f32 v[12:13], v[8:9], v[8:9]
    v_pk_mul_f32 v[14:15], v[10:11], v[10:11]
    v_pk_fma_f32 v[12:13], v[12:13], v[52:53], v[50:51] op_sel_hi:[1,0,0]
    v_pk_fma_f32 v[14:15], v[14:15], v[52:53], v[50:51] op_sel_hi:[1,0,0]
    v_pk_mul_f32 v[12:13], v[12:13], v[8:9]
    v_pk_mul_f32 v[14:15], v[14:15], v[10:11]
    v_exp_f32 v12, v12
    v_exp_f32 v13, v13
    v_exp_f32 v14, v14
    v_exp_f32 v15, v15
    v_pk_add_f32 v[12:13], v[12:13], v[52:53] op_sel:[0,1] op_sel_hi:[1,1]
    v_pk_add_f32 v[14:15], v[14:15], v[52:53] op_sel:[0,1] op_sel_hi:[1,1]
    v_rcp_f32 v12, v12
    v_rcp_f32 v13, v13
    v_rcp_f32 v14, v14
    v_rcp_f32 v15, v15
    v_pk_mul_f32 v[8:9], v[8:9], v[12:13]
    v_pk_mul_f32 v[10:11], v[10:11], v[14:15]
    v_cvt_pk_bf16_f32 v8, v8, v9
    v_cvt_pk_bf16_f32 v9, v10, v11
    s_cmp_lg_u32 s9, 0
    s_cbranch_scc1 Lsl_59
    buffer_store_dwordx2 v[8:9], v45, s[16:19], s69 offen
Lsd_60:
Lskip_56:
Lskip_50:
    s_cmp_lt_u32 s5, 18
    s_cbranch_scc0 Lskip_61
    s_lshl_b32 s15, s3, 10
    v_lshl_add_u32 v45, v0, 4, s15
    v_lshrrev_b32 v46, 2, v1
    v_mul_u32_u24 v46, 1152, v46
    v_lshl_add_u32 v46, v2, 4, v46
    v_add_u32 v45, 9216, v45
    s_mul_i32 s15, s11, 576
    s_lshl_b32 s70, s3, 6
    s_add_u32 s15, s15, s70
    s_add_u32 s15, s15, s14
    s_add_u32 s15, s15, 50688
    v_lshrrev_b32 v44, 3, v1
    v_lshlrev_b32 v44, 13, v44
    v_lshl_add_u32 v44, v2, 7, v44
    v_and_b32 v43, 7, v1
    v_lshl_add_u32 v44, v43, 4, v44
    s_lshl_b32 s68, s10, 14
    s_lshl_b32 s69, s4, 10
    s_add_u32 s68, s68, s69
    s_lshl_b32 s69, s11, 9
    s_add_u32 s68, s68, s69
    s_add_u32 s68, s68, 884736
    s_cmp_lg_u32 s3, 7
    s_cbranch_scc0 Lskip_62
Lpoll_63:
    buffer_load_dwordx4 v[8:11], v46, s[16:19], s15 offen sc1
    s_waitcnt vmcnt(0)
    v_max3_u32 v47, v8, v9, v10
    v_max_u32 v47, v47, v11
    v_cmp_eq_u32 vcc, -1, v47
    s_cbranch_vccz Lpd_64
    s_sub_u32 s8, s8, 1
    s_cbranch_scc0 Lpoll_63
    s_mov_b32 s8, 0
Lpd_64:
    v_mfma_f32_16x16x32_bf16 v[24:27], v[8:11], v[224:227], 0
    v_mfma_f32_16x16x32_bf16 v[28:31], v[8:11], v[228:231], 0
    v_mfma_f32_16x16x32_bf16 v[32:35], v[8:11], v[232:235], 0
    v_mfma_f32_16x16x32_bf16 v[36:39], v[8:11], v[236:239], 0
Lskip_62:
    s_cmp_eq_u32 s3, 7
    s_cbranch_scc0 Lskip_65
Lpoll_66:
    buffer_load_dwordx4 v[8:11], v46, s[16:19], s15 offen sc1
    buffer_load_dwordx4 v[12:15], v46, s[16:19], s15 offen offset:64 sc1
    s_waitcnt vmcnt(0)
    v_max3_u32 v47, v8, v9, v10
    v_max3_u32 v47, v47, v11, v12
    v_max3_u32 v47, v47, v13, v14
    v_max_u32 v47, v47, v15
    v_cmp_eq_u32 vcc, -1, v47
    s_cbranch_vccz Lpd_67
    s_sub_u32 s8, s8, 1
    s_cbranch_scc0 Lpoll_66
    s_mov_b32 s8, 0
Lpd_67:
    v_mfma_f32_16x16x32_bf16 v[24:27], v[8:11], v[224:227], 0
    v_mfma_f32_16x16x32_bf16 v[28:31], v[8:11], v[228:231], 0
    v_mfma_f32_16x16x32_bf16 v[32:35], v[8:11], v[232:235], 0
    v_mfma_f32_16x16x32_bf16 v[36:39], v[8:11], v[236:239], 0
    v_mfma_f32_16x16x32_bf16 v[24:27], v[12:15], v[240:243], v[24:27]
    v_mfma_f32_16x16x32_bf16 v[28:31], v[12:15], v[244:247], v[28:31]
    v_mfma_f32_16x16x32_bf16 v[32:35], v[12:15], v[248:251], v[32:35]
    v_mfma_f32_16x16x32_bf16 v[36:39], v[12:15], v[252:255], v[36:39]
Lskip_65:
    s_nop 5
    ds_write2_b32 v45, v24, v28 offset0:0 offset1:1
    s_nop 0
    ds_write2_b32 v45, v32, v36 offset0:2 offset1:3
    s_waitcnt lgkmcnt(0)
    s_barrier
    s_cmp_eq_u32 s3, 0
    s_cbranch_scc0 Lskip_68
    v_lshlrev_b32 v46, 4, v0
    ds_read_b128 v[8:11], v46 offset:9216
    ds_read_b128 v[12:15], v46 offset:10240
    ds_read_b128 v[16:19], v46 offset:11264
    ds_read_b128 v[20:23], v46 offset:12288
    ds_read_b128 v[24:27], v46 offset:13312
    ds_read_b128 v[28:31], v46 offset:14336
    ds_read_b128 v[32:35], v46 offset:15360
    ds_read_b128 v[36:39], v46 offset:16384
    s_waitcnt lgkmcnt(6)
    v_pk_add_f32 v[8:9], v[8:9], v[12:13]
    v_pk_add_f32 v[10:11], v[10:11], v[14:15]
    s_waitcnt lgkmcnt(5)
    v_pk_add_f32 v[8:9], v[8:9], v[16:17]
    v_pk_add_f32 v[10:11], v[10:11], v[18:19]
    s_waitcnt lgkmcnt(4)
    v_pk_add_f32 v[8:9], v[8:9], v[20:21]
    v_pk_add_f32 v[10:11], v[10:11], v[22:23]
    s_waitcnt lgkmcnt(3)
    v_pk_add_f32 v[8:9], v[8:9], v[24:25]
    v_pk_add_f32 v[10:11], v[10:11], v[26:27]
    s_waitcnt lgkmcnt(2)
    v_pk_add_f32 v[8:9], v[8:9], v[28:29]
    v_pk_add_f32 v[10:11], v[10:11], v[30:31]
    s_waitcnt lgkmcnt(1)
    v_pk_add_f32 v[8:9], v[8:9], v[32:33]
    v_pk_add_f32 v[10:11], v[10:11], v[34:35]
    s_waitcnt lgkmcnt(0)
    v_pk_add_f32 v[8:9], v[8:9], v[36:37]
    v_pk_add_f32 v[10:11], v[10:11], v[38:39]
    v_and_or_b32 v8, v8, v55, s6
    buffer_store_dwordx4 v[8:11], v44, s[16:19], s68 offen sc1
Lskip_68:
Lskip_61:
    s_cmp_lt_u32 s13, 18
    s_cbranch_scc0 Lskip_69
    s_lshl_b32 s68, s13, 13
    s_add_u32 s68, s68, 884736
    s_add_u32 s71, s68, 4096
    v_lshlrev_b32 v44, 4, v0
    s_add_u32 s69, s14, 41472
    s_lshl_b32 s70, s13, 3
    s_add_u32 s70, s70, s14
    s_add_u32 s70, s70, 61440
    v_lshlrev_b32 v45, 5, v0
    v_lshlrev_b32 v40, 16, v72
    v_and_b32 v41, 0xffff0000, v72
    v_lshlrev_b32 v42, 16, v73
    v_and_b32 v43, 0xffff0000, v73
    s_sleep 10
    v_lshlrev_b32 v6, 7, v0
    s_add_u32 s15, s14, 50688
    s_mov_b64 exec, 0x1ff
Lpoll_70:
    buffer_load_dword v4, v6, s[16:19], s15 offen sc1
    s_waitcnt vmcnt(0)
    v_max_u32 v5, v4, v4
    v_cmp_eq_u32 vcc, -1, v5
    s_cbranch_vccz Lpd_71
    s_sub_u32 s8, s8, 1
    s_cbranch_scc0 Lpoll_70
    s_mov_b32 s8, 0
Lpd_71:
    s_mov_b64 exec, -1
    s_sleep 19
Lpoll_72:
    buffer_load_dwordx4 v[8:11], v44, s[16:19], s68 offen offset:0 sc1
    buffer_load_dwordx4 v[12:15], v44, s[16:19], s68 offen offset:1024 sc1
    buffer_load_dwordx4 v[16:19], v44, s[16:19], s68 offen offset:2048 sc1
    buffer_load_dwordx4 v[20:23], v44, s[16:19], s68 offen offset:3072 sc1
    buffer_load_dwordx4 v[24:27], v44, s[16:19], s71 offen offset:0 sc1
    buffer_load_dwordx4 v[28:31], v44, s[16:19], s71 offen offset:1024 sc1
    buffer_load_dwordx4 v[32:35], v44, s[16:19], s71 offen offset:2048 sc1
    buffer_load_dwordx4 v[36:39], v44, s[16:19], s71 offen offset:3072 sc1
    s_waitcnt vmcnt(0)
    v_xor_b32 v8, s6, v8
    v_xor_b32 v12, s6, v12
    v_xor_b32 v16, s6, v16
    v_xor_b32 v20, s6, v20
    v_xor_b32 v24, s6, v24
    v_xor_b32 v28, s6, v28
    v_xor_b32 v32, s6, v32
    v_xor_b32 v36, s6, v36
    v_or3_b32 v46, v8, v12, v16
    v_or3_b32 v46, v46, v20, v24
    v_or3_b32 v46, v46, v28, v32
    v_or_b32 v46, v46, v36
    v_and_b32 v46, 0xff, v46
    v_cmp_ne_u32 vcc, 0, v46
    s_cbranch_vccz Lpd_73
    s_sub_u32 s8, s8, 1
    s_cbranch_scc0 Lpoll_72
    s_mov_b32 s8, 0
Lpd_73:
    v_pk_add_f32 v[56:57], v[8:9], v[12:13]
    v_pk_add_f32 v[58:59], v[10:11], v[14:15]
    v_pk_add_f32 v[60:61], v[16:17], v[20:21]
    v_pk_add_f32 v[62:63], v[18:19], v[22:23]
    v_pk_add_f32 v[64:65], v[24:25], v[28:29]
    v_pk_add_f32 v[66:67], v[26:27], v[30:31]
    v_pk_add_f32 v[68:69], v[32:33], v[36:37]
    v_pk_add_f32 v[70:71], v[34:35], v[38:39]
    v_pk_add_f32 v[56:57], v[56:57], v[60:61]
    v_pk_add_f32 v[58:59], v[58:59], v[62:63]
    v_pk_add_f32 v[64:65], v[64:65], v[68:69]
    v_pk_add_f32 v[66:67], v[66:67], v[70:71]
    v_pk_add_f32 v[56:57], v[56:57], v[64:65]
    v_pk_add_f32 v[58:59], v[58:59], v[66:67]
    s_nop 1
    v_permlane32_swap_b32 v56, v58
    v_permlane32_swap_b32 v57, v59
    v_add_f32 v56, v56, v58
    v_add_f32 v57, v57, v59
    v_cvt_pk_bf16_f32 v56, v56, v57
    v_and_b32 v57, 0xffff0000, v56
    v_lshlrev_b32 v56, 16, v56
    v_add_f32 v56, v56, v42
    v_add_f32 v57, v57, v43
    v_cvt_pk_bf16_f32 v56, v56, v57
    v_and_b32 v57, 0xffff0000, v56
    v_lshlrev_b32 v56, 16, v56
    v_add_f32 v56, v56, v40
    v_add_f32 v57, v57, v41
    v_cvt_pk_bf16_f32 v72, v56, v57
    s_cmp_lg_u32 s9, 0
    s_cbranch_scc1 Lsl_74
    buffer_store_dword v72, v74, s[16:19], s69 offen
Lsd_75:
    v_lshlrev_b32 v56, 16, v72
    v_and_b32 v57, 0xffff0000, v72
    v_add_f32 v58, v56, v57
    v_mul_f32 v59, v56, v56
    v_fmac_f32 v59, v57, v57
    v_add_f32_dpp v58, v58, v58 quad_perm:[1,0,3,2] row_mask:0xf bank_mask:0xf
    s_nop 0
    v_add_f32_dpp v59, v59, v59 quad_perm:[1,0,3,2] row_mask:0xf bank_mask:0xf
    v_add_f32_dpp v58, v58, v58 quad_perm:[2,3,0,1] row_mask:0xf bank_mask:0xf
    s_nop 0
    v_add_f32_dpp v59, v59, v59 quad_perm:[2,3,0,1] row_mask:0xf bank_mask:0xf
    v_add_f32_dpp v58, v58, v58 row_half_mirror row_mask:0xf bank_mask:0xf
    s_nop 0
    v_add_f32_dpp v59, v59, v59 row_half_mirror row_mask:0xf bank_mask:0xf
    v_mov_b32 v60, v58
    v_mov_b32 v61, v59
    s_nop 0
    v_permlane32_swap_b32 v60, v58
    v_permlane32_swap_b32 v61, v59
    v_add_f32 v58, v58, v60
    v_add_f32 v59, v59, v61
    s_mov_b32 exec_lo, 0x1010101
    s_mov_b32 exec_hi, 0x0
    s_cmp_lg_u32 s9, 0
    s_cbranch_scc1 Lsl_76
    buffer_store_dwordx2 v[58:59], v45, s[16:19], s70 offen
Lsd_77:
    s_mov_b64 exec, -1
    s_barrier
Lskip_69:
    s_cmp_ge_u32 s5, 18
    s_cbranch_scc0 Lskip_78
    s_cmp_ge_u32 s13, 18
    s_cbranch_scc0 Lskip_79
    s_barrier
Lskip_79:
Lskip_78:
    s_cmp_lt_u32 s5, 18
    s_cbranch_scc0 Lskip_80
    s_sleep 28
Lskip_80:
    s_cmp_lt_u32 s3, 5
    s_cbranch_scc0 Lskip_81
    s_lshl_b32 s15, s3, 10
    v_lshl_add_u32 v45, v0, 4, s15
    v_lshrrev_b32 v46, 2, v1
    v_mul_u32_u24 v46, 1152, v46
    v_lshl_add_u32 v46, v2, 4, v46
    v_add_u32 v45, 9216, v45
    s_mul_i32 s15, s66, 288
    s_lshl_b32 s70, s3, 6
    s_add_u32 s15, s15, s70
    s_add_u32 s15, s15, s14
    s_add_u32 s15, s15, 41472
    v_mov_b32 v8, 0
    v_mov_b32 v9, 0
    v_mov_b32 v10, 0
    v_mov_b32 v11, 0
    s_cmp_eq_u32 s3, 4
    s_cselect_b32 exec_hi, 0, -1
Lpoll_82:
    buffer_load_dwordx4 v[8:11], v46, s[16:19], s15 offen sc1
    s_waitcnt vmcnt(0)
    v_max3_u32 v47, v8, v9, v10
    v_max_u32 v47, v47, v11
    v_cmp_eq_u32 vcc, -1, v47
    s_cbranch_vccz Lpd_83
    s_sub_u32 s8, s8, 1
    s_cbranch_scc0 Lpoll_82
    s_mov_b32 s8, 0
Lpd_83:
    s_mov_b64 exec, -1
    v_mfma_f32_16x16x32_bf16 v[24:27], v[8:11], v[56:59], 0
    v_mfma_f32_16x16x32_bf16 v[28:31], v[8:11], v[60:63], 0
    v_mfma_f32_16x16x32_bf16 v[32:35], v[8:11], v[64:67], 0
    v_mfma_f32_16x16x32_bf16 v[36:39], v[8:11], v[68:71], 0
    s_nop 5
    ds_write2_b32 v45, v24, v28 offset0:0 offset1:1
    s_nop 0
    ds_write2_b32 v45, v32, v36 offset0:2 offset1:3
    s_waitcnt lgkmcnt(0)
Lskip_81:
    s_cmp_lg_u32 s3, 6
    s_cbranch_scc0 Lskip_84
    s_barrier
Lskip_84:
    s_cmp_eq_u32 s3, 6
    s_cbranch_scc0 Lskip_85
    v_lshlrev_b32 v46, 4, v0
    v_lshlrev_b32 v44, 8, v2
    v_lshl_add_u32 v44, v1, 4, v44
    s_add_u32 s68, s14, 61440
    v_mov_b32 v8, 0
    v_mov_b32 v9, 0
    v_mov_b32 v10, 0
    v_mov_b32 v11, 0
    s_mov_b32 exec_lo, 0x1ff01ff
    s_mov_b32 exec_hi, 0x1ff01ff
Lpoll_86:
    buffer_load_dwordx4 v[8:11], v44, s[16:19], s68 offen sc1
    s_waitcnt vmcnt(0)
    v_max3_u32 v47, v8, v9, v10
    v_max_u32 v47, v47, v11
    v_cmp_eq_u32 vcc, -1, v47
    s_cbranch_vccz Lpd_87
    s_sub_u32 s8, s8, 1
    s_cbranch_scc0 Lpoll_86
    s_mov_b32 s8, 0
Lpd_87:
    s_mov_b64 exec, -1
    v_add_f32 v48, v8, v10
    v_add_f32 v49, v9, v11
    s_nop 0
    v_add_f32_dpp v48, v48, v48 row_ror:8 row_mask:0xf bank_mask:0xf
    v_add_f32_dpp v49, v49, v49 row_ror:8 row_mask:0xf bank_mask:0xf
    s_nop 0
    v_add_f32_dpp v48, v48, v48 row_ror:4 row_mask:0xf bank_mask:0xf
    v_add_f32_dpp v49, v49, v49 row_ror:4 row_mask:0xf bank_mask:0xf
    s_nop 0
    v_add_f32_dpp v48, v48, v48 row_ror:2 row_mask:0xf bank_mask:0xf
    v_add_f32_dpp v49, v49, v49 row_ror:2 row_mask:0xf bank_mask:0xf
    s_nop 0
    v_add_f32_dpp v48, v48, v48 row_ror:1 row_mask:0xf bank_mask:0xf
    v_add_f32_dpp v49, v49, v49 row_ror:1 row_mask:0xf bank_mask:0xf
    v_mul_f32 v48, 0xbae38e39, v48
    v_mul_f32 v49, 0x3ae38e39, v49
    v_fma_f32 v49, -v48, v48, v49
    v_add_f32 v49, 0x3727c5ac, v49
    v_rsq_f32 v49, v49
    s_nop 0
    v_mul_f32 v49, 0x3e0293ee, v49
    v_lshlrev_b32 v44, 11, v2
    v_lshl_add_u32 v44, v1, 4, v44
    s_lshl_b32 s70, s4, 15
    s_lshl_b32 s71, s66, 13
    s_add_u32 s70, s70, s71
    s_lshl_b32 s71, s73, 8
    s_add_u32 s70, s70, s71
    s_add_u32 s70, s70, 327680
    s_barrier
    ds_read_b128 v[8:11], v46 offset:9216
    ds_read_b128 v[12:15], v46 offset:10240
    ds_read_b128 v[16:19], v46 offset:11264
    ds_read_b128 v[20:23], v46 offset:12288
    ds_read_b128 v[24:27], v46 offset:13312
    s_waitcnt lgkmcnt(3)
    v_pk_add_f32 v[8:9], v[8:9], v[12:13]
    v_pk_add_f32 v[10:11], v[10:11], v[14:15]
    s_waitcnt lgkmcnt(2)
    v_pk_add_f32 v[8:9], v[8:9], v[16:17]
    v_pk_add_f32 v[10:11], v[10:11], v[18:19]
    s_waitcnt lgkmcnt(1)
    v_pk_add_f32 v[8:9], v[8:9], v[20:21]
    v_pk_add_f32 v[10:11], v[10:11], v[22:23]
    s_waitcnt lgkmcnt(0)
    v_pk_add_f32 v[8:9], v[8:9], v[24:25]
    v_pk_add_f32 v[10:11], v[10:11], v[26:27]
    v_pk_fma_f32 v[8:9], v[56:57], v[48:49], v[8:9] op_sel_hi:[1,0,1]
    v_pk_fma_f32 v[10:11], v[58:59], v[48:49], v[10:11] op_sel_hi:[1,0,1]
    v_pk_mul_f32 v[8:9], v[8:9], v[48:49] op_sel:[0,1] op_sel_hi:[1,1]
    v_pk_mul_f32 v[10:11], v[10:11], v[48:49] op_sel:[0,1] op_sel_hi:[1,1]
    v_and_or_b32 v8, v8, v55, s6
    s_cmp_lg_u32 s9, 0
    s_cbranch_scc1 Lsl_88
    buffer_store_dwordx4 v[8:11], v44, s[16:19], s70 offen
Lsd_89:
Lskip_85:
    v_and_b32 v54, 1, v0
    v_lshlrev_b32 v54, 8, v54
    v_lshl_add_u32 v54, v2, 4, v54
    s_lshl_b32 s15, s3, 10
    v_lshl_add_u32 v46, v0, 5, s15
    s_lshl_b32 s15, s3, 3
    v_lshl_add_u32 v3, v0, 6, s15
    s_lshl_b32 s15, s3, 2
    v_lshl_add_u32 v45, v0, 3, s15
    v_and_b32 v7, 7, v0
    s_lshl_b32 s15, s3, 6
    v_lshl_add_u32 v7, v7, 3, s15
    s_lshl_b32 s62, s65, 1
    s_add_u32 s62, s62, s3
    s_lshl_b32 s60, s62, 12
    s_lshl_b32 s15, s64, 8
    s_add_u32 s60, s60, s15
    s_lshl_b32 s15, s66, 6
    s_add_u32 s60, s60, s15
    s_add_u32 s60, s60, s14
    s_add_u32 s60, s60, 16384
    s_lshl_b32 s61, s62, 9
    s_lshl_b32 s15, s64, 4
    s_add_u32 s61, s61, s15
    s_lshl_b32 s15, s66, 2
    s_add_u32 s61, s61, s15
    s_add_u32 s61, s61, s14
    s_add_u32 s61, s61, 34816
    v_lshlrev_b32 v44, 10, v2
    v_lshl_add_u32 v44, v1, 2, v44
    s_cmp_eq_u32 s3, 0
    s_cbranch_scc0 Lskip_90
    s_lshl_b32 s68, s4, 15
    s_lshl_b32 s69, s64, 11
    s_add_u32 s68, s68, s69
    s_lshl_b32 s69, s65, 10
    s_add_u32 s68, s68, s69
    s_add_u32 s68, s68, 327680
    s_add_u32 s69, s68, 8192
    s_add_u32 s70, s68, 16384
    s_add_u32 s71, s68, 24576
    v_lshlrev_b32 v47, 4, v0
Lpoll_91:
    buffer_load_dwordx4 v[8:11], v47, s[16:19], s68 offen sc1
    buffer_load_dwordx4 v[12:15], v47, s[16:19], s69 offen sc1
    buffer_load_dwordx4 v[16:19], v47, s[16:19], s70 offen sc1
    buffer_load_dwordx4 v[20:23], v47, s[16:19], s71 offen sc1
    s_waitcnt vmcnt(0)
    v_xor_b32 v8, s6, v8
    v_xor_b32 v12, s6, v12
    v_xor_b32 v16, s6, v16
    v_xor_b32 v20, s6, v20
    v_or3_b32 v4, v8, v12, v16
    v_or_b32 v4, v4, v20
    v_and_b32 v4, 0xff, v4
    v_cmp_ne_u32 vcc, 0, v4
    s_cbranch_vccz Lpd_92
    s_sub_u32 s8, s8, 1
    s_cbranch_scc0 Lpoll_91
    s_mov_b32 s8, 0
Lpd_92:
    v_pk_add_f32 v[8:9], v[8:9], v[12:13]
    v_pk_add_f32 v[10:11], v[10:11], v[14:15]
    v_pk_add_f32 v[16:17], v[16:17], v[20:21]
    v_pk_add_f32 v[18:19], v[18:19], v[22:23]
    v_pk_add_f32 v[8:9], v[8:9], v[16:17]
    v_pk_add_f32 v[10:11], v[10:11], v[18:19]
    v_cvt_pk_bf16_f32 v8, v8, v9
    v_cvt_pk_bf16_f32 v9, v10, v11
    v_lshlrev_b32 v10, 3, v0
    ds_write_b64 v10, v[8:9] offset:0
    s_waitcnt lgkmcnt(0)
Lskip_90:
    s_cmp_lt_u32 s13, 18
    s_cbranch_scc0 Lskip_93
    s_waitcnt vmcnt(0)
Lskip_93:
    s_barrier
    ds_read_b128 v[8:11], v54 offset:0
    ds_read_b128 v[12:15], v54 offset:64
    ds_read_b128 v[16:19], v54 offset:128
    ds_read_b128 v[20:23], v54 offset:192
    s_setprio 1
    s_waitcnt lgkmcnt(3)
    v_mfma_f32_16x16x32_bf16 v[24:27], v[128:131], v[8:11], 0
    s_waitcnt lgkmcnt(2)
    v_mfma_f32_16x16x32_bf16 v[24:27], v[132:135], v[12:15], v[24:27]
    s_waitcnt lgkmcnt(1)
    v_mfma_f32_16x16x32_bf16 v[24:27], v[136:139], v[16:19], v[24:27]
    s_waitcnt lgkmcnt(0)
    v_mfma_f32_16x16x32_bf16 v[24:27], v[140:143], v[20:23], v[24:27]
    v_mfma_f32_16x16x32_bf16 v[28:31], v[144:147], v[8:11], 0
    v_mfma_f32_16x16x32_bf16 v[28:31], v[148:151], v[12:15], v[28:31]
    v_mfma_f32_16x16x32_bf16 v[28:31], v[152:155], v[16:19], v[28:31]
    v_mfma_f32_16x16x32_bf16 v[28:31], v[156:159], v[20:23], v[28:31]
    v_mfma_f32_16x16x32_bf16 v[32:35], v[160:163], v[8:11], 0
    v_mfma_f32_16x16x32_bf16 v[32:35], v[164:167], v[12:15], v[32:35]
    v_mfma_f32_16x16x32_bf16 v[32:35], v[168:171], v[16:19], v[32:35]
    v_mfma_f32_16x16x32_bf16 v[32:35], v[172:175], v[20:23], v[32:35]
    v_mfma_f32_16x16x32_bf16 v[36:39], v[176:179], v[8:11], 0
    s_nop 2
    v_mov_b32_dpp v24, v28 quad_perm:[0,1,2,3] row_mask:0xf bank_mask:0x2
    v_mov_b32_dpp v25, v29 quad_perm:[0,1,2,3] row_mask:0xf bank_mask:0x2
    v_mfma_f32_16x16x32_bf16 v[36:39], v[180:183], v[12:15], v[36:39]
    v_mov_b32_dpp v26, v30 quad_perm:[0,1,2,3] row_mask:0xf bank_mask:0x2
    v_mov_b32_dpp v27, v31 quad_perm:[0,1,2,3] row_mask:0xf bank_mask:0x2
    v_mfma_f32_16x16x32_bf16 v[36:39], v[184:187], v[16:19], v[36:39]
    v_mov_b32_dpp v24, v32 quad_perm:[0,1,2,3] row_mask:0xf bank_mask:0x4
    v_mov_b32_dpp v25, v33 quad_perm:[0,1,2,3] row_mask:0xf bank_mask:0x4
    v_mfma_f32_16x16x32_bf16 v[36:39], v[188:191], v[20:23], v[36:39]
    v_mov_b32_dpp v26, v34 quad_perm:[0,1,2,3] row_mask:0xf bank_mask:0x4
    v_mov_b32_dpp v27, v35 quad_perm:[0,1,2,3] row_mask:0xf bank_mask:0x4
    s_setprio 0
    v_max3_f32 v53, v24, v25, v26
    v_max_f32 v53, v53, v27
    s_nop 1
    v_max_f32_dpp v53, v53, v53 row_ror:4 row_mask:0xf bank_mask:0xf
    s_nop 1
    v_max_f32_dpp v53, v53, v53 row_ror:8 row_mask:0xf bank_mask:0xf
    v_max3_f32 v52, v36, v37, v53
    v_max3_f32 v52, v38, v39, v52
    v_mov_b32 v54, v52
    v_mov_b32_dpp v24, v36 quad_perm:[0,1,2,3] row_mask:0xf bank_mask:0x8
    v_mov_b32_dpp v25, v37 quad_perm:[0,1,2,3] row_mask:0xf bank_mask:0x8
    v_permlane16_swap_b32 v54, v52
    v_max_f32 v52, v52, v54
    v_mov_b32 v54, v52
    v_mov_b32_dpp v26, v38 quad_perm:[0,1,2,3] row_mask:0xf bank_mask:0x8
    v_mov_b32_dpp v27, v39 quad_perm:[0,1,2,3] row_mask:0xf bank_mask:0x8
    v_permlane32_swap_b32 v54, v52
    v_max_f32 v52, v52, v54
    v_sub_f32 v48, v24, v52
    v_sub_f32 v49, v25, v52
    v_sub_f32 v50, v26, v52
    v_sub_f32 v51, v27, v52
    v_exp_f32 v48, v48
    v_exp_f32 v49, v49
    v_exp_f32 v50, v50
    v_exp_f32 v51, v51
    v_cvt_pk_bf16_f32 v40, v48, v49
    v_cvt_pk_bf16_f32 v41, v50, v51
    v_add_f32 v53, v48, v49
    v_mov_b32_dpp v42, v40 row_ror:12 row_mask:0xf bank_mask:0xf
    v_mov_b32_dpp v43, v41 row_ror:12 row_mask:0xf bank_mask:0xf
    s_nop 1
    v_mfma_f32_16x16x32_bf16 v[8:11], v[40:43], v[96:99], 0
    v_add_f32 v54, v50, v51
    v_mov_b32_dpp v48, v40 row_ror:8 row_mask:0xf bank_mask:0xf
    v_mfma_f32_16x16x32_bf16 v[12:15], v[40:43], v[100:103], 0
    v_mov_b32_dpp v49, v41 row_ror:8 row_mask:0xf bank_mask:0xf
    v_mov_b32_dpp v50, v40 row_ror:4 row_mask:0xf bank_mask:0xf
    v_mfma_f32_16x16x32_bf16 v[16:19], v[40:43], v[104:107], 0
    v_mov_b32_dpp v51, v41 row_ror:4 row_mask:0xf bank_mask:0xf
    v_add_f32 v53, v53, v54
    v_mfma_f32_16x16x32_bf16 v[20:23], v[40:43], v[108:111], 0
    s_nop 0
    v_add_f32_dpp v53, v53, v53 row_ror:4 row_mask:0xf bank_mask:0xf
    v_mfma_f32_16x16x32_bf16 v[24:27], v[40:43], v[112:115], 0
    s_nop 0
    v_add_f32_dpp v53, v53, v53 row_ror:8 row_mask:0xf bank_mask:0xf
    v_mfma_f32_16x16x32_bf16 v[28:31], v[40:43], v[116:119], 0
    v_mov_b32 v54, v53
    v_mfma_f32_16x16x32_bf16 v[32:35], v[40:43], v[120:123], 0
    s_nop 0
    v_permlane16_swap_b32 v54, v53
    v_mfma_f32_16x16x32_bf16 v[36:39], v[40:43], v[124:127], 0
    v_add_f32 v53, v53, v54
    v_mfma_f32_16x16x32_bf16 v[8:11], v[48:51], v[192:195], v[8:11]
    v_mov_b32 v54, v53
    v_mfma_f32_16x16x32_bf16 v[12:15], v[48:51], v[196:199], v[12:15]
    s_nop 0
    v_permlane32_swap_b32 v54, v53
    v_mfma_f32_16x16x32_bf16 v[16:19], v[48:51], v[200:203], v[16:19]
    v_add_f32 v53, v53, v54
    v_mfma_f32_16x16x32_bf16 v[20:23], v[48:51], v[204:207], v[20:23]
    v_mfma_f32_16x16x32_bf16 v[24:27], v[48:51], v[208:211], v[24:27]
    v_mfma_f32_16x16x32_bf16 v[28:31], v[48:51], v[212:215], v[28:31]
    v_mfma_f32_16x16x32_bf16 v[32:35], v[48:51], v[216:219], v[32:35]
    v_mfma_f32_16x16x32_bf16 v[36:39], v[48:51], v[220:223], v[36:39]
    s_mov_b64 exec, 3
    ds_write_b64 v3, v[52:53] offset:512
    s_mov_b64 exec, 0xffff
    ds_write2_b64 v46, v[8:9], v[12:13] offset0:128 offset1:192
    ds_write2_b64 v46, v[16:17], v[20:21] offset0:129 offset1:193
    s_nop 0
    ds_write2_b64 v46, v[24:25], v[28:29] offset0:130 offset1:194
    s_nop 0
    ds_write2_b64 v46, v[32:33], v[36:37] offset0:131 offset1:195
    s_mov_b64 exec, -1
    s_waitcnt lgkmcnt(0)
    s_barrier
    s_cmp_lt_u32 s3, 2
    s_cbranch_scc0 Lskip_94
    ds_read_b64 v[52:53], v7 offset:512
    ds_read2st64_b32 v[8:9], v45 offset0:4 offset1:6
    ds_read2st64_b32 v[10:11], v45 offset0:8 offset1:10
    ds_read2st64_b32 v[12:13], v45 offset0:12 offset1:14
    ds_read2st64_b32 v[14:15], v45 offset0:16 offset1:18
    ds_read2st64_b32 v[16:17], v45 offset0:20 offset1:22
    ds_read2st64_b32 v[18:19], v45 offset0:24 offset1:26
    ds_read2st64_b32 v[20:21], v45 offset0:28 offset1:30
    ds_read2st64_b32 v[22:23], v45 offset0:32 offset1:34
    v_lshlrev_b32 v29, 7, v0
    s_waitcnt lgkmcnt(8)
    v_max_f32_dpp v54, v52, v52 quad_perm:[1,0,3,2] row_mask:0xf bank_mask:0xf
    s_nop 1
    v_max_f32_dpp v54, v54, v54 quad_perm:[2,3,0,1] row_mask:0xf bank_mask:0xf
    s_nop 1
    v_max_f32_dpp v54, v54, v54 row_half_mirror row_mask:0xf bank_mask:0xf
    v_sub_f32 v52, v52, v54
    v_exp_f32 v52, v52
    s_nop 0
    v_mul_f32 v53, v53, v52
    v_readlane_b32 s20, v52, 0
    v_readlane_b32 s21, v52, 1
    v_add_f32_dpp v53, v53, v53 quad_perm:[1,0,3,2] row_mask:0xf bank_mask:0xf
    v_readlane_b32 s22, v52, 2
    v_readlane_b32 s23, v52, 3
    v_add_f32_dpp v53, v53, v53 quad_perm:[2,3,0,1] row_mask:0xf bank_mask:0xf
    v_readlane_b32 s24, v52, 4
    v_readlane_b32 s25, v52, 5
    v_add_f32_dpp v53, v53, v53 row_half_mirror row_mask:0xf bank_mask:0xf
    v_readlane_b32 s26, v52, 6
    v_readlane_b32 s27, v52, 7
    v_rcp_f32 v28, v53
    s_waitcnt lgkmcnt(0)
    v_pk_mul_f32 v[24:25], v[8:9], s[20:21] op_sel_hi:[1,0]
    v_pk_mul_f32 v[26:27], v[10:11], s[20:21] op_sel:[0,1] op_sel_hi:[1,1]
    v_pk_fma_f32 v[24:25], v[12:13], s[22:23], v[24:25] op_sel_hi:[1,0,1]
    v_pk_fma_f32 v[26:27], v[14:15], s[22:23], v[26:27] op_sel:[0,1,0] op_sel_hi:[1,1,1]
    v_pk_fma_f32 v[24:25], v[16:17], s[24:25], v[24:25] op_sel_hi:[1,0,1]
    v_pk_fma_f32 v[26:27], v[18:19], s[24:25], v[26:27] op_sel:[0,1,0] op_sel_hi:[1,1,1]
    v_pk_fma_f32 v[24:25], v[20:21], s[26:27], v[24:25] op_sel_hi:[1,0,1]
    v_pk_fma_f32 v[26:27], v[22:23], s[26:27], v[26:27] op_sel:[0,1,0] op_sel_hi:[1,1,1]
    v_log_f32 v53, v53
    v_pk_add_f32 v[24:25], v[24:25], v[26:27]
    v_mul_f32 v24, v24, v28
    v_mul_f32 v25, v25, v28
    v_cvt_pk_bf16_f32 v24, v24, v25
    v_add_f32 v53, v53, v54
    s_cmp_lg_u32 s9, 0
    s_cbranch_scc1 Lsl_95
    buffer_store_dword v24, v44, s[16:19], s60 offen
    s_mov_b64 exec, 15
    buffer_store_dword v53, v29, s[16:19], s61 offen
Lsd_96:
    s_mov_b64 exec, -1
Lskip_94:
    s_cmp_lt_u32 s5, 18
    s_cbranch_scc0 Lskip_97
    s_barrier
    s_lshr_b32 s68, s3, 2
    s_lshl_b32 s69, s11, 1
    s_add_u32 s68, s68, s69
    s_and_b32 s69, s3, 3
    s_lshl_b32 s70, s68, 12
    s_lshl_b32 s69, s69, 10
    s_add_u32 s70, s70, s69
    s_add_u32 s70, s70, s14
    s_add_u32 s70, s70, 16384
    s_lshl_b32 s71, s68, 9
    s_lshr_b32 s69, s69, 3
    s_add_u32 s71, s71, s69
    s_add_u32 s71, s71, s14
    s_add_u32 s71, s71, 34816
    v_lshlrev_b32 v42, 6, v1
    v_lshl_add_u32 v42, v2, 4, v42
    v_lshlrev_b32 v45, 4, v2
    s_lshl_b32 s15, s3, 10
    v_lshl_add_u32 v46, v0, 4, s15
    v_lshrrev_b32 v44, 3, v1
    v_lshlrev_b32 v44, 13, v44
    v_lshl_add_u32 v44, v2, 7, v44
    v_and_b32 v43, 7, v1
    v_lshl_add_u32 v44, v43, 4, v44
    s_lshl_b32 s68, s10, 14
    s_lshl_b32 s69, s4, 10
    s_add_u32 s68, s68, s69
    s_lshl_b32 s69, s11, 9
    s_add_u32 s68, s68, s69
    s_add_u32 s68, s68, 737280
Lpoll_98:
    buffer_load_dwordx4 v[8:11], v42, s[16:19], s70 offen sc1
    buffer_load_dwordx4 v[16:19], v45, s[16:19], s71 offen sc1
    s_waitcnt vmcnt(0)
    v_max3_u32 v47, v8, v9, v10
    v_max3_u32 v47, v47, v11, v16
    v_max3_u32 v47, v47, v17, v18
    v_max_u32 v47, v47, v19
    v_cmp_eq_u32 vcc, -1, v47
    s_cbranch_vccz Lpd_99
    s_sub_u32 s8, s8, 1
    s_cbranch_scc0 Lpoll_98
    s_mov_b32 s8, 0
Lpd_99:
    v_mfma_f32_16x16x32_bf16 v[24:27], v[8:11], v[72:75], 0
    v_mfma_f32_16x16x32_bf16 v[28:31], v[8:11], v[76:79], 0
    v_mfma_f32_16x16x32_bf16 v[32:35], v[8:11], v[80:83], 0
    v_mfma_f32_16x16x32_bf16 v[36:39], v[8:11], v[84:87], 0
    v_max3_f32 v20, v16, v17, v18
    v_max_f32 v20, v20, v19
    v_sub_f32 v16, v16, v20
    v_sub_f32 v17, v17, v20
    v_sub_f32 v18, v18, v20
    v_sub_f32 v19, v19, v20
    v_exp_f32 v16, v16
    v_exp_f32 v17, v17
    v_exp_f32 v18, v18
    v_exp_f32 v19, v19
    v_add_f32 v20, v16, v17
    v_add_f32 v21, v18, v19
    v_add_f32 v20, v20, v21
    v_rcp_f32 v20, v20
    s_nop 0
    v_pk_mul_f32 v[16:17], v[16:17], v[20:21] op_sel_hi:[1,0]
    v_pk_mul_f32 v[18:19], v[18:19], v[20:21] op_sel_hi:[1,0]
    v_pk_mul_f32 v[24:25], v[24:25], v[16:17]
    v_pk_mul_f32 v[28:29], v[28:29], v[16:17]
    v_pk_mul_f32 v[32:33], v[32:33], v[16:17]
    v_pk_mul_f32 v[36:37], v[36:37], v[16:17]
    v_pk_fma_f32 v[24:25], v[26:27], v[18:19], v[24:25]
    v_pk_fma_f32 v[28:29], v[30:31], v[18:19], v[28:29]
    v_pk_fma_f32 v[32:33], v[34:35], v[18:19], v[32:33]
    v_pk_fma_f32 v[36:37], v[38:39], v[18:19], v[36:37]
    v_add_f32 v12, v24, v25
    v_add_f32 v13, v28, v29
    v_add_f32 v14, v32, v33
    v_add_f32 v15, v36, v37
    ds_write_b128 v46, v[12:15] offset:9216
    s_waitcnt lgkmcnt(0)
    s_barrier
    s_cmp_eq_u32 s3, 0
    s_cbranch_scc0 Lskip_100
    v_lshlrev_b32 v46, 4, v0
    ds_read_b128 v[8:11], v46 offset:9216
    ds_read_b128 v[12:15], v46 offset:10240
    ds_read_b128 v[16:19], v46 offset:11264
    ds_read_b128 v[20:23], v46 offset:12288
    ds_read_b128 v[24:27], v46 offset:13312
    ds_read_b128 v[28:31], v46 offset:14336
    ds_read_b128 v[32:35], v46 offset:15360
    ds_read_b128 v[36:39], v46 offset:16384
    s_waitcnt lgkmcnt(6)
    v_pk_add_f32 v[8:9], v[8:9], v[12:13]
    v_pk_add_f32 v[10:11], v[10:11], v[14:15]
    s_waitcnt lgkmcnt(5)
    v_pk_add_f32 v[8:9], v[8:9], v[16:17]
    v_pk_add_f32 v[10:11], v[10:11], v[18:19]
    s_waitcnt lgkmcnt(4)
    v_pk_add_f32 v[8:9], v[8:9], v[20:21]
    v_pk_add_f32 v[10:11], v[10:11], v[22:23]
    s_waitcnt lgkmcnt(3)
    v_pk_add_f32 v[8:9], v[8:9], v[24:25]
    v_pk_add_f32 v[10:11], v[10:11], v[26:27]
    s_waitcnt lgkmcnt(2)
    v_pk_add_f32 v[8:9], v[8:9], v[28:29]
    v_pk_add_f32 v[10:11], v[10:11], v[30:31]
    s_waitcnt lgkmcnt(1)
    v_pk_add_f32 v[8:9], v[8:9], v[32:33]
    v_pk_add_f32 v[10:11], v[10:11], v[34:35]
    s_waitcnt lgkmcnt(0)
    v_pk_add_f32 v[8:9], v[8:9], v[36:37]
    v_pk_add_f32 v[10:11], v[10:11], v[38:39]
    v_and_or_b32 v8, v8, v55, s6
    buffer_store_dwordx4 v[8:11], v44, s[16:19], s68 offen sc1
Lskip_100:
Lskip_97:
    s_cmp_lt_u32 s13, 18
    s_cbranch_scc0 Lskip_101
    s_lshl_b32 s68, s13, 13
    s_add_u32 s68, s68, 737280
    s_add_u32 s71, s68, 4096
    v_lshlrev_b32 v44, 4, v0
    s_add_u32 s69, s14, 46080
    s_lshl_b32 s70, s13, 3
    s_add_u32 s70, s70, s14
    s_add_u32 s70, s70, 62464
    v_lshlrev_b32 v45, 5, v0
    v_lshlrev_b32 v40, 16, v72
    v_and_b32 v41, 0xffff0000, v72
    v_lshlrev_b32 v6, 9, v2
    v_lshl_add_u32 v6, v1, 2, v6
    s_add_u32 s15, s14, 34816
Lpoll_102:
    buffer_load_dword v4, v6, s[16:19], s15 offen sc1
    s_waitcnt vmcnt(0)
    v_max_u32 v5, v4, v4
    v_cmp_eq_u32 vcc, -1, v5
    s_cbranch_vccz Lpd_103
    s_sub_u32 s8, s8, 1
    s_cbranch_scc0 Lpoll_102
    s_mov_b32 s8, 0
Lpd_103:
    s_sleep 28
Lpoll_104:
    buffer_load_dwordx4 v[8:11], v44, s[16:19], s68 offen offset:0 sc1
    buffer_load_dwordx4 v[12:15], v44, s[16:19], s68 offen offset:1024 sc1
    buffer_load_dwordx4 v[16:19], v44, s[16:19], s68 offen offset:2048 sc1
    buffer_load_dwordx4 v[20:23], v44, s[16:19], s68 offen offset:3072 sc1
    buffer_load_dwordx4 v[24:27], v44, s[16:19], s71 offen offset:0 sc1
    buffer_load_dwordx4 v[28:31], v44, s[16:19], s71 offen offset:1024 sc1
    buffer_load_dwordx4 v[32:35], v44, s[16:19], s71 offen offset:2048 sc1
    buffer_load_dwordx4 v[36:39], v44, s[16:19], s71 offen offset:3072 sc1
    s_waitcnt vmcnt(0)
    v_xor_b32 v8, s6, v8
    v_xor_b32 v12, s6, v12
    v_xor_b32 v16, s6, v16
    v_xor_b32 v20, s6, v20
    v_xor_b32 v24, s6, v24
    v_xor_b32 v28, s6, v28
    v_xor_b32 v32, s6, v32
    v_xor_b32 v36, s6, v36
    v_or3_b32 v46, v8, v12, v16
    v_or3_b32 v46, v46, v20, v24
    v_or3_b32 v46, v46, v28, v32
    v_or_b32 v46, v46, v36
    v_and_b32 v46, 0xff, v46
    v_cmp_ne_u32 vcc, 0, v46
    s_cbranch_vccz Lpd_105
    s_sub_u32 s8, s8, 1
    s_cbranch_scc0 Lpoll_104
    s_mov_b32 s8, 0
Lpd_105:
    v_pk_add_f32 v[56:57], v[8:9], v[12:13]
    v_pk_add_f32 v[58:59], v[10:11], v[14:15]
    v_pk_add_f32 v[60:61], v[16:17], v[20:21]
    v_pk_add_f32 v[62:63], v[18:19], v[22:23]
    v_pk_add_f32 v[64:65], v[24:25], v[28:29]
    v_pk_add_f32 v[66:67], v[26:27], v[30:31]
    v_pk_add_f32 v[68:69], v[32:33], v[36:37]
    v_pk_add_f32 v[70:71], v[34:35], v[38:39]
    v_pk_add_f32 v[56:57], v[56:57], v[60:61]
    v_pk_add_f32 v[58:59], v[58:59], v[62:63]
    v_pk_add_f32 v[64:65], v[64:65], v[68:69]
    v_pk_add_f32 v[66:67], v[66:67], v[70:71]
    v_pk_add_f32 v[56:57], v[56:57], v[64:65]
    v_pk_add_f32 v[58:59], v[58:59], v[66:67]
    s_nop 1
    v_permlane32_swap_b32 v56, v58
    v_permlane32_swap_b32 v57, v59
    v_add_f32 v56, v56, v58
    v_add_f32 v57, v57, v59
    v_cvt_pk_bf16_f32 v56, v56, v57
    v_and_b32 v57, 0xffff0000, v56
    v_lshlrev_b32 v56, 16, v56
    v_add_f32 v56, v56, v40
    v_add_f32 v57, v57, v41
    v_cvt_pk_bf16_f32 v72, v56, v57
    s_cmp_lg_u32 s9, 0
    s_cbranch_scc1 Lsl_106
    buffer_store_dword v72, v74, s[16:19], s69 offen
Lsd_107:
    v_lshlrev_b32 v56, 16, v72
    v_and_b32 v57, 0xffff0000, v72
    v_add_f32 v58, v56, v57
    v_mul_f32 v59, v56, v56
    v_fmac_f32 v59, v57, v57
    v_add_f32_dpp v58, v58, v58 quad_perm:[1,0,3,2] row_mask:0xf bank_mask:0xf
    s_nop 0
    v_add_f32_dpp v59, v59, v59 quad_perm:[1,0,3,2] row_mask:0xf bank_mask:0xf
    v_add_f32_dpp v58, v58, v58 quad_perm:[2,3,0,1] row_mask:0xf bank_mask:0xf
    s_nop 0
    v_add_f32_dpp v59, v59, v59 quad_perm:[2,3,0,1] row_mask:0xf bank_mask:0xf
    v_add_f32_dpp v58, v58, v58 row_half_mirror row_mask:0xf bank_mask:0xf
    s_nop 0
    v_add_f32_dpp v59, v59, v59 row_half_mirror row_mask:0xf bank_mask:0xf
    v_mov_b32 v60, v58
    v_mov_b32 v61, v59
    s_nop 0
    v_permlane32_swap_b32 v60, v58
    v_permlane32_swap_b32 v61, v59
    v_add_f32 v58, v58, v60
    v_add_f32 v59, v59, v61
    s_mov_b32 exec_lo, 0x1010101
    s_mov_b32 exec_hi, 0x0
    s_cmp_lg_u32 s9, 0
    s_cbranch_scc1 Lsl_108
    buffer_store_dwordx2 v[58:59], v45, s[16:19], s70 offen
Lsd_109:
    s_mov_b64 exec, -1
    s_cmp_lt_u32 s12, 9
    s_cbranch_scc0 Lskip_110
    s_barrier
Lskip_110:
Lskip_101:
    s_cmp_lt_u32 s12, 9
    s_cbranch_scc0 Lskip_111
    s_cmp_lg_u32 s3, 7
    s_cbranch_scc0 Lskip_112
    s_barrier
Lskip_112:
    s_cmp_lt_u32 s3, 6
    s_cbranch_scc0 Lskip_113
    s_lshl_b32 s15, s3, 10
    v_lshl_add_u32 v45, v0, 4, s15
    v_lshrrev_b32 v46, 2, v1
    v_mul_u32_u24 v46, 1152, v46
    v_lshl_add_u32 v46, v2, 4, v46
    v_add_u32 v45, 9216, v45
    s_mul_i32 s15, s3, 192
    s_add_u32 s15, s15, s14
    s_add_u32 s15, s15, 46080
Lpoll_114:
    buffer_load_dwordx4 v[8:11], v46, s[16:19], s15 offen offset:0 sc1
    buffer_load_dwordx4 v[12:15], v46, s[16:19], s15 offen offset:64 sc1
    buffer_load_dwordx4 v[16:19], v46, s[16:19], s15 offen offset:128 sc1
    s_waitcnt vmcnt(0)
    v_max3_u32 v47, v8, v9, v10
    v_max3_u32 v47, v47, v11, v12
    v_max3_u32 v47, v47, v13, v14
    v_max3_u32 v47, v47, v15, v16
    v_max3_u32 v47, v47, v17, v18
    v_max_u32 v47, v47, v19
    v_cmp_eq_u32 vcc, -1, v47
    s_cbranch_vccz Lpd_115
    s_sub_u32 s8, s8, 1
    s_cbranch_scc0 Lpoll_114
    s_mov_b32 s8, 0
Lpd_115:
    v_mfma_f32_16x16x32_bf16 v[24:27], v[8:11], v[72:75], 0
    v_mfma_f32_16x16x32_bf16 v[28:31], v[8:11], v[76:79], 0
    v_mfma_f32_16x16x32_bf16 v[32:35], v[8:11], v[80:83], 0
    v_mfma_f32_16x16x32_bf16 v[36:39], v[8:11], v[84:87], 0
    v_mfma_f32_16x16x32_bf16 v[24:27], v[12:15], v[224:227], v[24:27]
    v_mfma_f32_16x16x32_bf16 v[28:31], v[12:15], v[228:231], v[28:31]
    v_mfma_f32_16x16x32_bf16 v[32:35], v[12:15], v[232:235], v[32:35]
    v_mfma_f32_16x16x32_bf16 v[36:39], v[12:15], v[236:239], v[36:39]
    v_mfma_f32_16x16x32_bf16 v[24:27], v[16:19], v[240:243], v[24:27]
    v_mfma_f32_16x16x32_bf16 v[28:31], v[16:19], v[244:247], v[28:31]
    v_mfma_f32_16x16x32_bf16 v[32:35], v[16:19], v[248:251], v[32:35]
    v_mfma_f32_16x16x32_bf16 v[36:39], v[16:19], v[252:255], v[36:39]
    s_nop 5
    ds_write2_b32 v45, v24, v28 offset0:0 offset1:1
    s_nop 0
    ds_write2_b32 v45, v32, v36 offset0:2 offset1:3
    s_waitcnt lgkmcnt(0)
    s_barrier
Lskip_113:
    s_cmp_eq_u32 s3, 7
    s_cbranch_scc0 Lskip_116
    s_barrier
Lskip_116:
    s_cmp_eq_u32 s3, 6
    s_cbranch_scc0 Lskip_117
    v_mul_u32_u24 v45, 1152, v2
    v_lshl_add_u32 v45, v1, 3, v45
    s_lshl_b32 s69, s12, 7
    s_add_u32 s69, s69, s14
    s_add_u32 s69, s69, 55296
    s_mov_b32 s70, 0xbdd2d3e8
    v_mov_b32 v50, 0xc0135761
    v_mov_b32 v52, s70
    v_mov_b32 v53, 1.0
    v_lshlrev_b32 v46, 4, v0
    v_lshlrev_b32 v44, 8, v2
    v_lshl_add_u32 v44, v1, 4, v44
    s_add_u32 s68, s14, 62464
    v_mov_b32 v8, 0
    v_mov_b32 v9, 0
    v_mov_b32 v10, 0
    v_mov_b32 v11, 0
    s_mov_b32 exec_lo, 0x1ff01ff
    s_mov_b32 exec_hi, 0x1ff01ff
Lpoll_118:
    buffer_load_dwordx4 v[8:11], v44, s[16:19], s68 offen sc1
    s_waitcnt vmcnt(0)
    v_max3_u32 v47, v8, v9, v10
    v_max_u32 v47, v47, v11
    v_cmp_eq_u32 vcc, -1, v47
    s_cbranch_vccz Lpd_119
    s_sub_u32 s8, s8, 1
    s_cbranch_scc0 Lpoll_118
    s_mov_b32 s8, 0
Lpd_119:
    s_mov_b64 exec, -1
    v_add_f32 v48, v8, v10
    v_add_f32 v49, v9, v11
    s_nop 0
    v_add_f32_dpp v48, v48, v48 row_ror:8 row_mask:0xf bank_mask:0xf
    v_add_f32_dpp v49, v49, v49 row_ror:8 row_mask:0xf bank_mask:0xf
    s_nop 0
    v_add_f32_dpp v48, v48, v48 row_ror:4 row_mask:0xf bank_mask:0xf
    v_add_f32_dpp v49, v49, v49 row_ror:4 row_mask:0xf bank_mask:0xf
    s_nop 0
    v_add_f32_dpp v48, v48, v48 row_ror:2 row_mask:0xf bank_mask:0xf
    v_add_f32_dpp v49, v49, v49 row_ror:2 row_mask:0xf bank_mask:0xf
    s_nop 0
    v_add_f32_dpp v48, v48, v48 row_ror:1 row_mask:0xf bank_mask:0xf
    v_add_f32_dpp v49, v49, v49 row_ror:1 row_mask:0xf bank_mask:0xf
    v_mul_f32 v48, 0xbae38e39, v48
    v_mul_f32 v49, 0x3ae38e39, v49
    v_fma_f32 v49, -v48, v48, v49
    v_add_f32 v49, 0x3727c5ac, v49
    v_rsq_f32 v49, v49
    s_barrier
    ds_read_b128 v[8:11], v46 offset:9216
    ds_read_b128 v[12:15], v46 offset:10240
    ds_read_b128 v[16:19], v46 offset:11264
    ds_read_b128 v[20:23], v46 offset:12288
    ds_read_b128 v[24:27], v46 offset:13312
    ds_read_b128 v[28:31], v46 offset:14336
    s_waitcnt lgkmcnt(4)
    v_pk_add_f32 v[8:9], v[8:9], v[12:13]
    v_pk_add_f32 v[10:11], v[10:11], v[14:15]
    s_waitcnt lgkmcnt(3)
    v_pk_add_f32 v[8:9], v[8:9], v[16:17]
    v_pk_add_f32 v[10:11], v[10:11], v[18:19]
    s_waitcnt lgkmcnt(2)
    v_pk_add_f32 v[8:9], v[8:9], v[20:21]
    v_pk_add_f32 v[10:11], v[10:11], v[22:23]
    s_waitcnt lgkmcnt(1)
    v_pk_add_f32 v[8:9], v[8:9], v[24:25]
    v_pk_add_f32 v[10:11], v[10:11], v[26:27]
    s_waitcnt lgkmcnt(0)
    v_pk_add_f32 v[8:9], v[8:9], v[28:29]
    v_pk_add_f32 v[10:11], v[10:11], v[30:31]
    v_pk_fma_f32 v[8:9], v[60:61], v[48:49], v[8:9] op_sel_hi:[1,0,1]
    v_pk_fma_f32 v[10:11], v[62:63], v[48:49], v[10:11] op_sel_hi:[1,0,1]
    v_pk_fma_f32 v[8:9], v[8:9], v[48:49], v[88:89] op_sel:[0,1,0] op_sel_hi:[1,1,1]
    v_pk_fma_f32 v[10:11], v[10:11], v[48:49], v[90:91] op_sel:[0,1,0] op_sel_hi:[1,1,1]
    v_pk_mul_f32 v[12:13], v[8:9], v[8:9]
    v_pk_mul_f32 v[14:15], v[10:11], v[10:11]
    v_pk_fma_f32 v[12:13], v[12:13], v[52:53], v[50:51] op_sel_hi:[1,0,0]
    v_pk_fma_f32 v[14:15], v[14:15], v[52:53], v[50:51] op_sel_hi:[1,0,0]
    v_pk_mul_f32 v[12:13], v[12:13], v[8:9]
    v_pk_mul_f32 v[14:15], v[14:15], v[10:11]
    v_exp_f32 v12, v12
    v_exp_f32 v13, v13
    v_exp_f32 v14, v14
    v_exp_f32 v15, v15
    v_pk_add_f32 v[12:13], v[12:13], v[52:53] op_sel:[0,1] op_sel_hi:[1,1]
    v_pk_add_f32 v[14:15], v[14:15], v[52:53] op_sel:[0,1] op_sel_hi:[1,1]
    v_rcp_f32 v12, v12
    v_rcp_f32 v13, v13
    v_rcp_f32 v14, v14
    v_rcp_f32 v15, v15
    v_pk_mul_f32 v[8:9], v[8:9], v[12:13]
    v_pk_mul_f32 v[10:11], v[10:11], v[14:15]
    v_cvt_pk_bf16_f32 v8, v8, v9
    v_cvt_pk_bf16_f32 v9, v10, v11
    s_cmp_lg_u32 s9, 0
    s_cbranch_scc1 Lsl_120
    buffer_store_dwordx2 v[8:9], v45, s[16:19], s69 offen
Lsd_121:
Lskip_117:
Lskip_111:
    s_cmp_lt_u32 s5, 18
    s_cbranch_scc0 Lskip_122
    s_lshl_b32 s15, s3, 10
    v_lshl_add_u32 v45, v0, 4, s15
    v_lshrrev_b32 v46, 2, v1
    v_mul_u32_u24 v46, 1152, v46
    v_lshl_add_u32 v46, v2, 4, v46
    v_add_u32 v45, 9216, v45
    s_mul_i32 s15, s11, 576
    s_lshl_b32 s70, s3, 6
    s_add_u32 s15, s15, s70
    s_add_u32 s15, s15, s14
    s_add_u32 s15, s15, 55296
    v_lshrrev_b32 v44, 3, v1
    v_lshlrev_b32 v44, 13, v44
    v_lshl_add_u32 v44, v2, 7, v44
    v_and_b32 v43, 7, v1
    v_lshl_add_u32 v44, v43, 4, v44
    s_lshl_b32 s68, s10, 14
    s_lshl_b32 s69, s4, 10
    s_add_u32 s68, s68, s69
    s_lshl_b32 s69, s11, 9
    s_add_u32 s68, s68, s69
    s_add_u32 s68, s68, 1032192
    s_sleep 44
    s_cmp_lg_u32 s3, 7
    s_cbranch_scc0 Lskip_123
Lpoll_124:
    buffer_load_dwordx4 v[8:11], v46, s[16:19], s15 offen sc1
    s_waitcnt vmcnt(0)
    v_max3_u32 v47, v8, v9, v10
    v_max_u32 v47, v47, v11
    v_cmp_eq_u32 vcc, -1, v47
    s_cbranch_vccz Lpd_125
    s_sub_u32 s8, s8, 1
    s_cbranch_scc0 Lpoll_124
    s_mov_b32 s8, 0
Lpd_125:
    v_mfma_f32_16x16x32_bf16 v[24:27], v[8:11], v[224:227], 0
    v_mfma_f32_16x16x32_bf16 v[28:31], v[8:11], v[228:231], 0
    v_mfma_f32_16x16x32_bf16 v[32:35], v[8:11], v[232:235], 0
    v_mfma_f32_16x16x32_bf16 v[36:39], v[8:11], v[236:239], 0
Lskip_123:
    s_cmp_eq_u32 s3, 7
    s_cbranch_scc0 Lskip_126
Lpoll_127:
    buffer_load_dwordx4 v[8:11], v46, s[16:19], s15 offen sc1
    buffer_load_dwordx4 v[12:15], v46, s[16:19], s15 offen offset:64 sc1
    s_waitcnt vmcnt(0)
    v_max3_u32 v47, v8, v9, v10
    v_max3_u32 v47, v47, v11, v12
    v_max3_u32 v47, v47, v13, v14
    v_max_u32 v47, v47, v15
    v_cmp_eq_u32 vcc, -1, v47
    s_cbranch_vccz Lpd_128
    s_sub_u32 s8, s8, 1
    s_cbranch_scc0 Lpoll_127
    s_mov_b32 s8, 0
Lpd_128:
    v_mfma_f32_16x16x32_bf16 v[24:27], v[8:11], v[224:227], 0
    v_mfma_f32_16x16x32_bf16 v[28:31], v[8:11], v[228:231], 0
    v_mfma_f32_16x16x32_bf16 v[32:35], v[8:11], v[232:235], 0
    v_mfma_f32_16x16x32_bf16 v[36:39], v[8:11], v[236:239], 0
    v_mfma_f32_16x16x32_bf16 v[24:27], v[12:15], v[240:243], v[24:27]
    v_mfma_f32_16x16x32_bf16 v[28:31], v[12:15], v[244:247], v[28:31]
    v_mfma_f32_16x16x32_bf16 v[32:35], v[12:15], v[248:251], v[32:35]
    v_mfma_f32_16x16x32_bf16 v[36:39], v[12:15], v[252:255], v[36:39]
Lskip_126:
    s_nop 5
    ds_write2_b32 v45, v24, v28 offset0:0 offset1:1
    s_nop 0
    ds_write2_b32 v45, v32, v36 offset0:2 offset1:3
    s_waitcnt lgkmcnt(0)
    s_barrier
    s_cmp_eq_u32 s3, 0
    s_cbranch_scc0 Lskip_129
    v_lshlrev_b32 v46, 4, v0
    ds_read_b128 v[8:11], v46 offset:9216
    ds_read_b128 v[12:15], v46 offset:10240
    ds_read_b128 v[16:19], v46 offset:11264
    ds_read_b128 v[20:23], v46 offset:12288
    ds_read_b128 v[24:27], v46 offset:13312
    ds_read_b128 v[28:31], v46 offset:14336
    ds_read_b128 v[32:35], v46 offset:15360
    ds_read_b128 v[36:39], v46 offset:16384
    s_waitcnt lgkmcnt(6)
    v_pk_add_f32 v[8:9], v[8:9], v[12:13]
    v_pk_add_f32 v[10:11], v[10:11], v[14:15]
    s_waitcnt lgkmcnt(5)
    v_pk_add_f32 v[8:9], v[8:9], v[16:17]
    v_pk_add_f32 v[10:11], v[10:11], v[18:19]
    s_waitcnt lgkmcnt(4)
    v_pk_add_f32 v[8:9], v[8:9], v[20:21]
    v_pk_add_f32 v[10:11], v[10:11], v[22:23]
    s_waitcnt lgkmcnt(3)
    v_pk_add_f32 v[8:9], v[8:9], v[24:25]
    v_pk_add_f32 v[10:11], v[10:11], v[26:27]
    s_waitcnt lgkmcnt(2)
    v_pk_add_f32 v[8:9], v[8:9], v[28:29]
    v_pk_add_f32 v[10:11], v[10:11], v[30:31]
    s_waitcnt lgkmcnt(1)
    v_pk_add_f32 v[8:9], v[8:9], v[32:33]
    v_pk_add_f32 v[10:11], v[10:11], v[34:35]
    s_waitcnt lgkmcnt(0)
    v_pk_add_f32 v[8:9], v[8:9], v[36:37]
    v_pk_add_f32 v[10:11], v[10:11], v[38:39]
    v_and_or_b32 v8, v8, v55, s6
    buffer_store_dwordx4 v[8:11], v44, s[16:19], s68 offen sc1
Lskip_129:
Lskip_122:
    s_cmp_lt_u32 s13, 18
    s_cbranch_scc0 Lskip_130
    s_and_b32 s68, s13, 7
    s_cmp_eq_u32 s68, s4
    s_cbranch_scc0 Lskip_131
    s_lshl_b32 s68, s13, 13
    s_add_u32 s68, s68, 1032192
    s_add_u32 s71, s68, 4096
    v_lshlrev_b32 v44, 4, v0
    s_mov_b32 s28, s52
    s_mov_b32 s29, s53
    s_mov_b32 s30, 4608
    s_mov_b32 s31, 0x20000
    v_lshlrev_b32 v40, 16, v72
    v_and_b32 v41, 0xffff0000, v72
    v_lshlrev_b32 v42, 16, v73
    v_and_b32 v43, 0xffff0000, v73
    s_sleep 10
    v_lshlrev_b32 v6, 7, v0
    s_add_u32 s15, s14, 55296
    s_mov_b64 exec, 0x1ff
Lpoll_132:
    buffer_load_dword v4, v6, s[16:19], s15 offen sc1
    s_waitcnt vmcnt(0)
    v_max_u32 v5, v4, v4
    v_cmp_eq_u32 vcc, -1, v5
    s_cbranch_vccz Lpd_133
    s_sub_u32 s8, s8, 1
    s_cbranch_scc0 Lpoll_132
    s_mov_b32 s8, 0
Lpd_133:
    s_mov_b64 exec, -1
    s_sleep 19
Lpoll_134:
    buffer_load_dwordx4 v[8:11], v44, s[16:19], s68 offen offset:0 sc1
    buffer_load_dwordx4 v[12:15], v44, s[16:19], s68 offen offset:1024 sc1
    buffer_load_dwordx4 v[16:19], v44, s[16:19], s68 offen offset:2048 sc1
    buffer_load_dwordx4 v[20:23], v44, s[16:19], s68 offen offset:3072 sc1
    buffer_load_dwordx4 v[24:27], v44, s[16:19], s71 offen offset:0 sc1
    buffer_load_dwordx4 v[28:31], v44, s[16:19], s71 offen offset:1024 sc1
    buffer_load_dwordx4 v[32:35], v44, s[16:19], s71 offen offset:2048 sc1
    buffer_load_dwordx4 v[36:39], v44, s[16:19], s71 offen offset:3072 sc1
    s_waitcnt vmcnt(0)
    v_xor_b32 v8, s6, v8
    v_xor_b32 v12, s6, v12
    v_xor_b32 v16, s6, v16
    v_xor_b32 v20, s6, v20
    v_xor_b32 v24, s6, v24
    v_xor_b32 v28, s6, v28
    v_xor_b32 v32, s6, v32
    v_xor_b32 v36, s6, v36
    v_or3_b32 v46, v8, v12, v16
    v_or3_b32 v46, v46, v20, v24
    v_or3_b32 v46, v46, v28, v32
    v_or_b32 v46, v46, v36
    v_and_b32 v46, 0xff, v46
    v_cmp_ne_u32 vcc, 0, v46
    s_cbranch_vccz Lpd_135
    s_sub_u32 s8, s8, 1
    s_cbranch_scc0 Lpoll_134
    s_mov_b32 s8, 0
Lpd_135:
    v_pk_add_f32 v[56:57], v[8:9], v[12:13]
    v_pk_add_f32 v[58:59], v[10:11], v[14:15]
    v_pk_add_f32 v[60:61], v[16:17], v[20:21]
    v_pk_add_f32 v[62:63], v[18:19], v[22:23]
    v_pk_add_f32 v[64:65], v[24:25], v[28:29]
    v_pk_add_f32 v[66:67], v[26:27], v[30:31]
    v_pk_add_f32 v[68:69], v[32:33], v[36:37]
    v_pk_add_f32 v[70:71], v[34:35], v[38:39]
    v_pk_add_f32 v[56:57], v[56:57], v[60:61]
    v_pk_add_f32 v[58:59], v[58:59], v[62:63]
    v_pk_add_f32 v[64:65], v[64:65], v[68:69]
    v_pk_add_f32 v[66:67], v[66:67], v[70:71]
    v_pk_add_f32 v[56:57], v[56:57], v[64:65]
    v_pk_add_f32 v[58:59], v[58:59], v[66:67]
    s_nop 1
    v_permlane32_swap_b32 v56, v58
    v_permlane32_swap_b32 v57, v59
    v_add_f32 v56, v56, v58
    v_add_f32 v57, v57, v59
    v_cvt_pk_bf16_f32 v56, v56, v57
    v_and_b32 v57, 0xffff0000, v56
    v_lshlrev_b32 v56, 16, v56
    v_add_f32 v56, v56, v42
    v_add_f32 v57, v57, v43
    v_cvt_pk_bf16_f32 v56, v56, v57
    v_and_b32 v57, 0xffff0000, v56
    v_lshlrev_b32 v56, 16, v56
    v_add_f32 v56, v56, v40
    v_add_f32 v57, v57, v41
    v_cvt_pk_bf16_f32 v72, v56, v57
    buffer_store_dword v72, v74, s[28:31], 0 offen
    s_cmp_eq_u32 s13, 0
    s_cbranch_scc0 Lskip_136
    v_mov_b32 v56, s7
    s_mov_b64 exec, 1
    buffer_store_dword v56, off, s[16:19], 0 sc1
    s_mov_b64 exec, -1
Lskip_136:
Lskip_131:
Lskip_130:
L_end:
    s_endpgm
Lsl_29:
    buffer_store_dword v24, v44, s[16:19], s60 offen sc1
    s_mov_b64 exec, 15
    buffer_store_dword v53, v29, s[16:19], s61 offen sc1
    s_branch Lsd_30
Lsl_45:
    buffer_store_dword v72, v74, s[16:19], s69 offen sc1
    s_branch Lsd_46
Lsl_47:
    buffer_store_dwordx2 v[58:59], v45, s[16:19], s70 offen sc1
    s_branch Lsd_48
Lsl_59:
    buffer_store_dwordx2 v[8:9], v45, s[16:19], s69 offen sc1
    s_branch Lsd_60
Lsl_74:
    buffer_store_dword v72, v74, s[16:19], s69 offen sc1
    s_branch Lsd_75
Lsl_76:
    buffer_store_dwordx2 v[58:59], v45, s[16:19], s70 offen sc1
    s_branch Lsd_77
Lsl_88:
    buffer_store_dwordx4 v[8:11], v44, s[16:19], s70 offen sc1
    s_branch Lsd_89
Lsl_95:
    buffer_store_dword v24, v44, s[16:19], s60 offen sc1
    s_mov_b64 exec, 15
    buffer_store_dword v53, v29, s[16:19], s61 offen sc1
    s_branch Lsd_96
Lsl_106:
    buffer_store_dword v72, v74, s[16:19], s69 offen sc1
    s_branch Lsd_107
Lsl_108:
    buffer_store_dwordx2 v[58:59], v45, s[16:19], s70 offen sc1
    s_branch Lsd_109
Lsl_120:
    buffer_store_dwordx2 v[8:9], v45, s[16:19], s69 offen sc1
    s_branch Lsd_121
.section .rodata,"a"
.p2align 6
.amdhsa_kernel interleave_layers__sliding_block_cached__dense_activation_gelu__decode_kernel
  .amdhsa_next_free_vgpr 256
  .amdhsa_next_free_sgpr 102
  .amdhsa_accum_offset 256
  .amdhsa_group_segment_fixed_size 0
  .amdhsa_kernarg_size 104
  .amdhsa_user_sgpr_count 2
  .amdhsa_user_sgpr_kernarg_segment_ptr 1
  .amdhsa_system_sgpr_workgroup_id_x 1
.end_amdhsa_kernel
```
